```python
import torch

def _softmax(x, axis=-1):
    return torch.softmax(x, dim=axis)
def _gelu(x):
    return torch.nn.functional.gelu(x, approximate="tanh")
def _silu(x):
    return torch.nn.functional.silu(x)
def _sigmoid(x):
    return torch.sigmoid(x)
def _layernorm(x, axis=-1, eps=1e-5):
    m = x.mean(dim=axis, keepdim=True)
    v = x.var(dim=axis, keepdim=True, unbiased=False)
    return (x - m) / torch.sqrt(v + eps)
def _scatter_add(tgt, idx, src, axis=0):
    return tgt.clone().index_add_(axis, idx, src)
def _segment_sum(src, seg, n):
    out = torch.zeros((n,) + src.shape[1:], dtype=src.dtype)
    return out.index_add_(0, seg, src)
def _pad(x, pw):
    flat = tuple(v for pair in reversed(pw) for v in pair)
    return torch.nn.functional.pad(x, flat)

kernel_name = 'recurrent_scan__gqa_block_cached__geglu_ffn__decode'

def setup_inputs():

    _w = (lambda a: (lambda t: t.to(torch.bfloat16) if t.is_floating_point() else t)(torch.as_tensor(a)))
    def _A_setup():
        B, Sq, D = 2, 1, 512
        Hq, Hkv, Sk, Dh = 32, 32, 8192, 128
        assert Hq % Hkv == 0, (Hq, Hkv)
        return {
            "x": _w((lambda *s: torch.randn(*s, dtype=torch.bfloat16) * 0.05)(B, Sq, D)),
            "k_cache": _w((lambda *s: torch.randn(*s, dtype=torch.bfloat16) * 1.6)(B, Hkv, Sk, Dh)),
            "v_cache": _w((lambda *s: torch.randn(*s, dtype=torch.bfloat16) * 0.2)(B, Hkv, Sk, Dh)),
            "wq": _w((lambda *s: torch.randn(*s, dtype=torch.bfloat16) * 1.6)(D, Hq * Dh) * (D ** -0.5)),
            "wo": _w((lambda *s: torch.randn(*s, dtype=torch.bfloat16) * 0.2)(Hq * Dh, D) * ((Hq * Dh) ** -0.5)),
        }
    _A_in = _A_setup()

    def _B_setup():
        B, S, D, F = 2, 1, 512, 1376
        return {
            "x": _w((lambda *s: torch.randn(*s, dtype=torch.bfloat16) * 0.05)(B, S, D)),
            "w_gate": _w((lambda *s: torch.randn(*s, dtype=torch.bfloat16) * 0.1)(D, F)),
            "w_up": _w((lambda *s: torch.randn(*s, dtype=torch.bfloat16) * 0.1)(D, F)),
            "w_down": _w((lambda *s: torch.randn(*s, dtype=torch.bfloat16) * 0.1)(F, D)),
        }
    _B_in = _B_setup()

    return {
        "A_x": _A_in["x"],
        "A_k_cache": _A_in["k_cache"],
        "A_v_cache": _A_in["v_cache"],
        "A_wq": _A_in["wq"],
        "A_wo": _A_in["wo"],
        "B_x": _B_in["x"],
        "B_w_gate": _B_in["w_gate"],
        "B_w_up": _B_in["w_up"],
        "B_w_down": _B_in["w_down"],
    }

def reference(A_x, A_k_cache, A_v_cache, A_wq, A_wo, B_x, B_w_gate, B_w_up, B_w_down):
    def _A_ref(x, k_cache, v_cache, wq, wo):
        B, Sq, D = x.shape
        Hq, Dh = 32, 128
        Hkv = k_cache.shape[1]
        rep = Hq // Hkv
        q = (lambda x, *d: x.permute(*d))((x @ wq).reshape(B, Sq, Hq, Dh), 0, 2, 1, 3)
        k = (lambda x, n, axis: torch.repeat_interleave(x, n, dim=axis))(k_cache, rep, axis=1)
        v = (lambda x, n, axis: torch.repeat_interleave(x, n, dim=axis))(v_cache, rep, axis=1)
        scores = torch.einsum("bhqd,bhkd->bhqk", q, k) * (Dh ** -0.5)
        p = _softmax(scores, axis=-1)
        o = torch.einsum("bhqk,bhkd->bhqd", p, v)
        return (lambda x, *d: x.permute(*d))(o, 0, 2, 1, 3).reshape(B, Sq, Hq * Dh) @ wo

    def _B_ref(x, w_gate, w_up, w_down):
        return (_gelu(x @ w_gate) * (x @ w_up)) @ w_down

    x = A_x
    xn = _layernorm(x, axis=-1)
    s = _A_ref(xn, A_k_cache, A_v_cache, A_wq, A_wo)
    g = _silu(_B_ref(xn, B_w_gate, B_w_up, B_w_down))
    return x + s * g
```

```asm
; @launch kernel=recurrent_scan__gqa_block_cached__geglu_ffn__decode_kernel grid=(256,1,1) block=(512,1,1) lds=86528
; @launch kernel=final_kernel grid=(16,1,1) block=(256,1,1) lds=8192
.amdgcn_target "amdgcn-amd-amdhsa--gfx950"
.text
.globl recurrent_scan__gqa_block_cached__geglu_ffn__decode_kernel
.p2align 8
.type recurrent_scan__gqa_block_cached__geglu_ffn__decode_kernel,@function
recurrent_scan__gqa_block_cached__geglu_ffn__decode_kernel:
    s_setprio 3
    s_load_dwordx4 s[4:7], s[0:1], 0
    s_load_dwordx4 s[8:11], s[0:1], 16
    s_load_dwordx2 s[12:13], s[0:1], 32
    s_load_dwordx2 s[14:15], s[0:1], 88
    s_load_dwordx4 s[44:47], s[0:1], 48
    s_load_dwordx2 s[48:49], s[0:1], 64
    s_cmp_ge_u32 s2, 256
    s_cbranch_scc1 L_k1_end
    v_readfirstlane_b32 s19, v0
    v_and_b32 v1, 63, v0
    v_lshlrev_b32 v2, 4, v1
    s_lshr_b32 s19, s19, 6
    s_mov_b32 s28, 0x3e0293ee
    s_mov_b32 s29, 0xffff0000
    s_and_b32 s17, s2, 7
    s_lshr_b32 s3, s2, 3
    s_and_b32 s3, s3, 3
    s_lshl_b32 s3, s3, 3
    s_add_u32 s17, s17, s3
    s_lshr_b32 s3, s2, 5
    s_lshr_b32 s16, s3, 2
    s_and_b32 s18, s3, 3
    s_lshl_b32 s34, s16, 5
    s_add_u32 s34, s34, s17
    s_and_b32 s3, s2, 31
    s_lshl_b32 s42, s16, 5
    s_add_u32 s42, s42, s3
    s_mul_i32 s38, s18, 67
    s_sub_u32 s38, s38, 11
    s_mov_b32 s39, 67
    s_cmp_eq_u32 s18, 3
    s_cselect_b32 s39, 66, s39
    s_cmp_eq_u32 s18, 0
    s_cselect_b32 s38, 0, s38
    s_cselect_b32 s39, 56, s39
    s_cselect_b32 s41, 1, 0
    s_lshl_b32 s36, s18, 6
    s_cmp_lt_u32 s42, 43
    s_cselect_b32 s38, s38, s36
    s_cselect_b32 s39, s39, 64
    s_cselect_b32 s41, s41, 0
    s_and_b32 s36, s42, 7
    s_lshr_b32 s37, s42, 3
    s_min_u32 s3, s36, 3
    s_mul_i32 s36, s36, 5
    s_add_u32 s36, s36, s3
    s_add_u32 s42, s36, s37
    s_sub_u32 s40, s39, s19
    s_add_u32 s40, s40, 7
    s_lshr_b32 s40, s40, 3
    s_lshl_b32 s35, s34, 21
    s_lshl_b32 s36, s38, 13
    s_add_u32 s35, s35, s36
    s_lshl_b32 s36, s19, 13
    s_add_u32 s36, s36, 4096
    v_add_u32 v3, s36, v2
    v_lshrrev_b32 v28, 4, v1
    v_and_b32 v29, 15, v1
    s_lshr_b32 s43, s2, 5
    s_add_u32 s43, s43, s19
    s_and_b32 s43, s43, 7
    v_lshlrev_b32 v26, 13, v28
    v_lshl_add_u32 v26, v29, 4, v26
    s_lshl_b32 s36, s43, 19
    v_add_u32 v26, s36, v26
    v_lshl_add_u32 v27, v29, 2, v28
    s_lshl_b32 s36, s43, 6
    v_add_u32 v27, s36, v27
    v_lshlrev_b32 v27, 1, v27
    s_lshl_b32 s36, s19, 6
    v_lshrrev_b32 v61, 2, v1
    v_add_u32 v61, s36, v61
    v_and_b32 v62, 3, v1
    s_mov_b32 s37, 2752
    v_mul_lo_u32 v63, v61, s37
    v_lshl_add_u32 v63, v62, 4, v63
    v_lshlrev_b32 v61, 1, v61
    s_lshl_b32 s37, s16, 10
    s_lshl_b32 s38, s17, 8
    s_lshl_b32 s39, s17, 17
    s_waitcnt lgkmcnt(0)
    s_add_u32 s24, s4, s37
    s_addc_u32 s25, s5, 0
    global_load_dwordx4 v[16:19], v2, s[24:25]
    global_load_ushort v24, v27, s[24:25]
    s_add_u32 s24, s10, s38
    s_addc_u32 s25, s11, 0
    s_add_u32 s20, s6, s35
    s_addc_u32 s21, s7, 0
    s_add_u32 s22, s8, s35
    s_addc_u32 s23, s9, 0
    s_add_u32 s26, s12, s39
    s_addc_u32 s27, s13, 0
    global_load_dwordx4 v[192:195], v26, s[24:25]
    s_add_u32 s24, s24, 32768
    s_addc_u32 s25, s25, 0
    global_load_dwordx4 v[196:199], v26, s[24:25]
    s_add_u32 s24, s24, 32768
    s_addc_u32 s25, s25, 0
    global_load_dwordx4 v[200:203], v26, s[24:25]
    s_add_u32 s24, s24, 32768
    s_addc_u32 s25, s25, 0
    global_load_dwordx4 v[204:207], v26, s[24:25]
    s_add_u32 s24, s24, 32768
    s_addc_u32 s25, s25, 0
    global_load_dwordx4 v[208:211], v26, s[24:25]
    s_add_u32 s24, s24, 32768
    s_addc_u32 s25, s25, 0
    global_load_dwordx4 v[212:215], v26, s[24:25]
    s_add_u32 s24, s24, 32768
    s_addc_u32 s25, s25, 0
    global_load_dwordx4 v[216:219], v26, s[24:25]
    s_add_u32 s24, s24, 32768
    s_addc_u32 s25, s25, 0
    global_load_dwordx4 v[220:223], v26, s[24:25]
    s_add_u32 s24, s24, 32768
    s_addc_u32 s25, s25, 0
    global_load_dwordx4 v[224:227], v26, s[24:25]
    s_add_u32 s24, s24, 32768
    s_addc_u32 s25, s25, 0
    global_load_dwordx4 v[228:231], v26, s[24:25]
    s_add_u32 s24, s24, 32768
    s_addc_u32 s25, s25, 0
    global_load_dwordx4 v[232:235], v26, s[24:25]
    s_add_u32 s24, s24, 32768
    s_addc_u32 s25, s25, 0
    global_load_dwordx4 v[236:239], v26, s[24:25]
    s_add_u32 s24, s24, 32768
    s_addc_u32 s25, s25, 0
    global_load_dwordx4 v[240:243], v26, s[24:25]
    s_add_u32 s24, s24, 32768
    s_addc_u32 s25, s25, 0
    global_load_dwordx4 v[244:247], v26, s[24:25]
    s_add_u32 s24, s24, 32768
    s_addc_u32 s25, s25, 0
    global_load_dwordx4 v[248:251], v26, s[24:25]
    s_add_u32 s24, s24, 32768
    s_addc_u32 s25, s25, 0
    global_load_dwordx4 v[252:255], v26, s[24:25]
    global_load_dwordx4 v[40:43], v2, s[4:5]
    global_load_dwordx4 v[44:47], v2, s[4:5] offset:1024
    global_load_ushort v32, v61, s[4:5] offset:0
    global_load_ushort v33, v61, s[4:5] offset:32
    global_load_ushort v34, v61, s[4:5] offset:64
    global_load_ushort v35, v61, s[4:5] offset:96
    global_load_ushort v36, v61, s[4:5] offset:1024
    global_load_ushort v37, v61, s[4:5] offset:1056
    global_load_ushort v38, v61, s[4:5] offset:1088
    global_load_ushort v39, v61, s[4:5] offset:1120
    s_setprio 0
    global_load_dwordx4 v[64:67], v3, s[20:21] offset:-4096 nt
    global_load_dwordx4 v[68:71], v3, s[20:21] offset:-3072 nt
    global_load_dwordx4 v[72:75], v3, s[20:21] offset:-2048 nt
    global_load_dwordx4 v[76:79], v3, s[20:21] offset:-1024 nt
    global_load_dwordx4 v[80:83], v3, s[20:21] offset:0 nt
    global_load_dwordx4 v[84:87], v3, s[20:21] offset:1024 nt
    global_load_dwordx4 v[88:91], v3, s[20:21] offset:2048 nt
    global_load_dwordx4 v[92:95], v3, s[20:21] offset:3072 nt
    s_add_u32 s20, s20, 65536
    s_addc_u32 s21, s21, 0
    global_load_dwordx4 v[96:99], v3, s[22:23] offset:-4096 nt
    global_load_dwordx4 v[100:103], v3, s[22:23] offset:-3072 nt
    global_load_dwordx4 v[104:107], v3, s[22:23] offset:-2048 nt
    global_load_dwordx4 v[108:111], v3, s[22:23] offset:-1024 nt
    global_load_dwordx4 v[112:115], v3, s[22:23] offset:0 nt
    global_load_dwordx4 v[116:119], v3, s[22:23] offset:1024 nt
    global_load_dwordx4 v[120:123], v3, s[22:23] offset:2048 nt
    global_load_dwordx4 v[124:127], v3, s[22:23] offset:3072 nt
    s_add_u32 s22, s22, 65536
    s_addc_u32 s23, s23, 0
    global_load_dwordx4 v[128:131], v3, s[20:21] offset:-4096 nt
    global_load_dwordx4 v[132:135], v3, s[20:21] offset:-3072 nt
    global_load_dwordx4 v[136:139], v3, s[20:21] offset:-2048 nt
    global_load_dwordx4 v[140:143], v3, s[20:21] offset:-1024 nt
    global_load_dwordx4 v[144:147], v3, s[20:21] offset:0 nt
    global_load_dwordx4 v[148:151], v3, s[20:21] offset:1024 nt
    global_load_dwordx4 v[152:155], v3, s[20:21] offset:2048 nt
    global_load_dwordx4 v[156:159], v3, s[20:21] offset:3072 nt
    s_add_u32 s20, s20, 65536
    s_addc_u32 s21, s21, 0
    global_load_dwordx4 v[160:163], v3, s[22:23] offset:-4096 nt
    global_load_dwordx4 v[164:167], v3, s[22:23] offset:-3072 nt
    global_load_dwordx4 v[168:171], v3, s[22:23] offset:-2048 nt
    global_load_dwordx4 v[172:175], v3, s[22:23] offset:-1024 nt
    global_load_dwordx4 v[176:179], v3, s[22:23] offset:0 nt
    global_load_dwordx4 v[180:183], v3, s[22:23] offset:1024 nt
    global_load_dwordx4 v[184:187], v3, s[22:23] offset:2048 nt
    global_load_dwordx4 v[188:191], v3, s[22:23] offset:3072 nt
    s_add_u32 s22, s22, 65536
    s_addc_u32 s23, s23, 0
    s_waitcnt vmcnt(58)
    v_lshlrev_b32 v20, 16, v16
    v_and_b32 v21, 0xffff0000, v16
    v_lshlrev_b32 v22, 16, v17
    v_and_b32 v23, 0xffff0000, v17
    v_lshlrev_b32 v28, 16, v18
    v_and_b32 v29, 0xffff0000, v18
    v_lshlrev_b32 v30, 16, v19
    v_and_b32 v31, 0xffff0000, v19
    v_add_f32 v27, v20, v21
    v_add_f32 v27, v27, v22
    v_add_f32 v27, v27, v23
    v_add_f32 v27, v27, v28
    v_add_f32 v27, v27, v29
    v_add_f32 v27, v27, v30
    v_add_f32 v27, v27, v31
    s_nop 1
    v_add_f32_dpp v27, v27, v27 quad_perm:[1,0,3,2] row_mask:0xf bank_mask:0xf
    s_nop 1
    v_add_f32_dpp v27, v27, v27 quad_perm:[2,3,0,1] row_mask:0xf bank_mask:0xf
    s_nop 1
    v_add_f32_dpp v27, v27, v27 row_half_mirror row_mask:0xf bank_mask:0xf
    s_nop 1
    v_add_f32_dpp v27, v27, v27 row_mirror row_mask:0xf bank_mask:0xf
    s_nop 0
    v_readlane_b32 s30, v27, 0
    v_readlane_b32 s31, v27, 16
    v_readlane_b32 s32, v27, 32
    v_readlane_b32 s33, v27, 48
    s_nop 1
    v_mov_b32 v27, s30
    v_add_f32 v27, s31, v27
    v_add_f32 v27, s32, v27
    v_add_f32 v27, s33, v27
    v_mul_f32 v27, 0x3b000000, v27
    v_sub_f32 v20, v20, v27
    v_sub_f32 v21, v21, v27
    v_sub_f32 v22, v22, v27
    v_sub_f32 v23, v23, v27
    v_sub_f32 v28, v28, v27
    v_sub_f32 v29, v29, v27
    v_sub_f32 v30, v30, v27
    v_sub_f32 v31, v31, v27
    v_mul_f32 v26, v20, v20
    v_fmac_f32 v26, v21, v21
    v_fmac_f32 v26, v22, v22
    v_fmac_f32 v26, v23, v23
    v_fmac_f32 v26, v28, v28
    v_fmac_f32 v26, v29, v29
    v_fmac_f32 v26, v30, v30
    v_fmac_f32 v26, v31, v31
    s_nop 1
    v_add_f32_dpp v26, v26, v26 quad_perm:[1,0,3,2] row_mask:0xf bank_mask:0xf
    s_nop 1
    v_add_f32_dpp v26, v26, v26 quad_perm:[2,3,0,1] row_mask:0xf bank_mask:0xf
    s_nop 1
    v_add_f32_dpp v26, v26, v26 row_half_mirror row_mask:0xf bank_mask:0xf
    s_nop 1
    v_add_f32_dpp v26, v26, v26 row_mirror row_mask:0xf bank_mask:0xf
    s_nop 0
    v_readlane_b32 s30, v26, 0
    v_readlane_b32 s31, v26, 16
    v_readlane_b32 s32, v26, 32
    v_readlane_b32 s33, v26, 48
    s_nop 1
    v_mov_b32 v26, s30
    v_add_f32 v26, s31, v26
    v_add_f32 v26, s32, v26
    v_add_f32 v26, s33, v26
    v_mul_f32 v26, 0x3b000000, v26
    v_cvt_pk_bf16_f32 v4, v27, v27
    v_and_b32 v4, 0xffff0000, v4
    v_cvt_pk_bf16_f32 v26, v26, v26
    v_and_b32 v26, 0xffff0000, v26
    v_add_f32 v26, 0x3727c5ac, v26
    v_cvt_pk_bf16_f32 v26, v26, v26
    v_and_b32 v26, 0xffff0000, v26
    v_sqrt_f32 v26, v26
    s_nop 0
    v_cvt_pk_bf16_f32 v5, v26, v26
    v_and_b32 v5, 0xffff0000, v5
    v_rcp_f32 v6, v5
    s_nop 0
    v_lshlrev_b32 v27, 16, v24
    v_sub_f32 v27, v27, v4
    v_cvt_pk_bf16_f32 v27, v27, v27
    v_and_b32 v27, 0xffff0000, v27
    v_mul_f32 v26, v27, v6
    v_fma_f32 v27, -v26, v5, v27
    v_fmac_f32 v26, v27, v6
    v_cvt_pk_bf16_f32 v25, v26, v26
    v_and_b32 v25, 0xffff0000, v25
    v_mov_b32 v8, 0
    v_mov_b32 v9, 0
    v_mov_b32 v10, 0
    v_mov_b32 v11, 0
    v_mov_b32 v12, 0
    v_mov_b32 v13, 0
    v_mov_b32 v14, 0
    v_mov_b32 v15, 0
    s_waitcnt vmcnt(50)
    v_lshlrev_b32 v16, 16, v192
    v_and_b32 v17, s29, v192
    v_lshlrev_b32 v18, 16, v193
    v_and_b32 v19, s29, v193
    v_lshlrev_b32 v20, 16, v194
    v_and_b32 v21, s29, v194
    v_lshlrev_b32 v22, 16, v195
    v_and_b32 v23, s29, v195
    v_fmac_f32_dpp v8, v25, v16 row_newbcast:0 row_mask:0xf bank_mask:0xf
    v_fmac_f32_dpp v9, v25, v17 row_newbcast:0 row_mask:0xf bank_mask:0xf
    v_fmac_f32_dpp v10, v25, v18 row_newbcast:0 row_mask:0xf bank_mask:0xf
    v_fmac_f32_dpp v11, v25, v19 row_newbcast:0 row_mask:0xf bank_mask:0xf
    v_fmac_f32_dpp v12, v25, v20 row_newbcast:0 row_mask:0xf bank_mask:0xf
    v_fmac_f32_dpp v13, v25, v21 row_newbcast:0 row_mask:0xf bank_mask:0xf
    v_fmac_f32_dpp v14, v25, v22 row_newbcast:0 row_mask:0xf bank_mask:0xf
    v_fmac_f32_dpp v15, v25, v23 row_newbcast:0 row_mask:0xf bank_mask:0xf
    v_lshlrev_b32 v16, 16, v196
    v_and_b32 v17, s29, v196
    v_lshlrev_b32 v18, 16, v197
    v_and_b32 v19, s29, v197
    v_lshlrev_b32 v20, 16, v198
    v_and_b32 v21, s29, v198
    v_lshlrev_b32 v22, 16, v199
    v_and_b32 v23, s29, v199
    v_fmac_f32_dpp v8, v25, v16 row_newbcast:1 row_mask:0xf bank_mask:0xf
    v_fmac_f32_dpp v9, v25, v17 row_newbcast:1 row_mask:0xf bank_mask:0xf
    v_fmac_f32_dpp v10, v25, v18 row_newbcast:1 row_mask:0xf bank_mask:0xf
    v_fmac_f32_dpp v11, v25, v19 row_newbcast:1 row_mask:0xf bank_mask:0xf
    v_fmac_f32_dpp v12, v25, v20 row_newbcast:1 row_mask:0xf bank_mask:0xf
    v_fmac_f32_dpp v13, v25, v21 row_newbcast:1 row_mask:0xf bank_mask:0xf
    v_fmac_f32_dpp v14, v25, v22 row_newbcast:1 row_mask:0xf bank_mask:0xf
    v_fmac_f32_dpp v15, v25, v23 row_newbcast:1 row_mask:0xf bank_mask:0xf
    v_lshlrev_b32 v16, 16, v200
    v_and_b32 v17, s29, v200
    v_lshlrev_b32 v18, 16, v201
    v_and_b32 v19, s29, v201
    v_lshlrev_b32 v20, 16, v202
    v_and_b32 v21, s29, v202
    v_lshlrev_b32 v22, 16, v203
    v_and_b32 v23, s29, v203
    v_fmac_f32_dpp v8, v25, v16 row_newbcast:2 row_mask:0xf bank_mask:0xf
    v_fmac_f32_dpp v9, v25, v17 row_newbcast:2 row_mask:0xf bank_mask:0xf
    v_fmac_f32_dpp v10, v25, v18 row_newbcast:2 row_mask:0xf bank_mask:0xf
    v_fmac_f32_dpp v11, v25, v19 row_newbcast:2 row_mask:0xf bank_mask:0xf
    v_fmac_f32_dpp v12, v25, v20 row_newbcast:2 row_mask:0xf bank_mask:0xf
    v_fmac_f32_dpp v13, v25, v21 row_newbcast:2 row_mask:0xf bank_mask:0xf
    v_fmac_f32_dpp v14, v25, v22 row_newbcast:2 row_mask:0xf bank_mask:0xf
    v_fmac_f32_dpp v15, v25, v23 row_newbcast:2 row_mask:0xf bank_mask:0xf
    v_lshlrev_b32 v16, 16, v204
    v_and_b32 v17, s29, v204
    v_lshlrev_b32 v18, 16, v205
    v_and_b32 v19, s29, v205
    v_lshlrev_b32 v20, 16, v206
    v_and_b32 v21, s29, v206
    v_lshlrev_b32 v22, 16, v207
    v_and_b32 v23, s29, v207
    v_fmac_f32_dpp v8, v25, v16 row_newbcast:3 row_mask:0xf bank_mask:0xf
    v_fmac_f32_dpp v9, v25, v17 row_newbcast:3 row_mask:0xf bank_mask:0xf
    v_fmac_f32_dpp v10, v25, v18 row_newbcast:3 row_mask:0xf bank_mask:0xf
    v_fmac_f32_dpp v11, v25, v19 row_newbcast:3 row_mask:0xf bank_mask:0xf
    v_fmac_f32_dpp v12, v25, v20 row_newbcast:3 row_mask:0xf bank_mask:0xf
    v_fmac_f32_dpp v13, v25, v21 row_newbcast:3 row_mask:0xf bank_mask:0xf
    v_fmac_f32_dpp v14, v25, v22 row_newbcast:3 row_mask:0xf bank_mask:0xf
    v_fmac_f32_dpp v15, v25, v23 row_newbcast:3 row_mask:0xf bank_mask:0xf
    v_lshlrev_b32 v16, 16, v208
    v_and_b32 v17, s29, v208
    v_lshlrev_b32 v18, 16, v209
    v_and_b32 v19, s29, v209
    v_lshlrev_b32 v20, 16, v210
    v_and_b32 v21, s29, v210
    v_lshlrev_b32 v22, 16, v211
    v_and_b32 v23, s29, v211
    v_fmac_f32_dpp v8, v25, v16 row_newbcast:4 row_mask:0xf bank_mask:0xf
    v_fmac_f32_dpp v9, v25, v17 row_newbcast:4 row_mask:0xf bank_mask:0xf
    v_fmac_f32_dpp v10, v25, v18 row_newbcast:4 row_mask:0xf bank_mask:0xf
    v_fmac_f32_dpp v11, v25, v19 row_newbcast:4 row_mask:0xf bank_mask:0xf
    v_fmac_f32_dpp v12, v25, v20 row_newbcast:4 row_mask:0xf bank_mask:0xf
    v_fmac_f32_dpp v13, v25, v21 row_newbcast:4 row_mask:0xf bank_mask:0xf
    v_fmac_f32_dpp v14, v25, v22 row_newbcast:4 row_mask:0xf bank_mask:0xf
    v_fmac_f32_dpp v15, v25, v23 row_newbcast:4 row_mask:0xf bank_mask:0xf
    v_lshlrev_b32 v16, 16, v212
    v_and_b32 v17, s29, v212
    v_lshlrev_b32 v18, 16, v213
    v_and_b32 v19, s29, v213
    v_lshlrev_b32 v20, 16, v214
    v_and_b32 v21, s29, v214
    v_lshlrev_b32 v22, 16, v215
    v_and_b32 v23, s29, v215
    v_fmac_f32_dpp v8, v25, v16 row_newbcast:5 row_mask:0xf bank_mask:0xf
    v_fmac_f32_dpp v9, v25, v17 row_newbcast:5 row_mask:0xf bank_mask:0xf
    v_fmac_f32_dpp v10, v25, v18 row_newbcast:5 row_mask:0xf bank_mask:0xf
    v_fmac_f32_dpp v11, v25, v19 row_newbcast:5 row_mask:0xf bank_mask:0xf
    v_fmac_f32_dpp v12, v25, v20 row_newbcast:5 row_mask:0xf bank_mask:0xf
    v_fmac_f32_dpp v13, v25, v21 row_newbcast:5 row_mask:0xf bank_mask:0xf
    v_fmac_f32_dpp v14, v25, v22 row_newbcast:5 row_mask:0xf bank_mask:0xf
    v_fmac_f32_dpp v15, v25, v23 row_newbcast:5 row_mask:0xf bank_mask:0xf
    v_lshlrev_b32 v16, 16, v216
    v_and_b32 v17, s29, v216
    v_lshlrev_b32 v18, 16, v217
    v_and_b32 v19, s29, v217
    v_lshlrev_b32 v20, 16, v218
    v_and_b32 v21, s29, v218
    v_lshlrev_b32 v22, 16, v219
    v_and_b32 v23, s29, v219
    v_fmac_f32_dpp v8, v25, v16 row_newbcast:6 row_mask:0xf bank_mask:0xf
    v_fmac_f32_dpp v9, v25, v17 row_newbcast:6 row_mask:0xf bank_mask:0xf
    v_fmac_f32_dpp v10, v25, v18 row_newbcast:6 row_mask:0xf bank_mask:0xf
    v_fmac_f32_dpp v11, v25, v19 row_newbcast:6 row_mask:0xf bank_mask:0xf
    v_fmac_f32_dpp v12, v25, v20 row_newbcast:6 row_mask:0xf bank_mask:0xf
    v_fmac_f32_dpp v13, v25, v21 row_newbcast:6 row_mask:0xf bank_mask:0xf
    v_fmac_f32_dpp v14, v25, v22 row_newbcast:6 row_mask:0xf bank_mask:0xf
    v_fmac_f32_dpp v15, v25, v23 row_newbcast:6 row_mask:0xf bank_mask:0xf
    v_lshlrev_b32 v16, 16, v220
    v_and_b32 v17, s29, v220
    v_lshlrev_b32 v18, 16, v221
    v_and_b32 v19, s29, v221
    v_lshlrev_b32 v20, 16, v222
    v_and_b32 v21, s29, v222
    v_lshlrev_b32 v22, 16, v223
    v_and_b32 v23, s29, v223
    v_fmac_f32_dpp v8, v25, v16 row_newbcast:7 row_mask:0xf bank_mask:0xf
    v_fmac_f32_dpp v9, v25, v17 row_newbcast:7 row_mask:0xf bank_mask:0xf
    v_fmac_f32_dpp v10, v25, v18 row_newbcast:7 row_mask:0xf bank_mask:0xf
    v_fmac_f32_dpp v11, v25, v19 row_newbcast:7 row_mask:0xf bank_mask:0xf
    v_fmac_f32_dpp v12, v25, v20 row_newbcast:7 row_mask:0xf bank_mask:0xf
    v_fmac_f32_dpp v13, v25, v21 row_newbcast:7 row_mask:0xf bank_mask:0xf
    v_fmac_f32_dpp v14, v25, v22 row_newbcast:7 row_mask:0xf bank_mask:0xf
    v_fmac_f32_dpp v15, v25, v23 row_newbcast:7 row_mask:0xf bank_mask:0xf
    s_waitcnt vmcnt(42)
    v_lshlrev_b32 v16, 16, v224
    v_and_b32 v17, s29, v224
    v_lshlrev_b32 v18, 16, v225
    v_and_b32 v19, s29, v225
    v_lshlrev_b32 v20, 16, v226
    v_and_b32 v21, s29, v226
    v_lshlrev_b32 v22, 16, v227
    v_and_b32 v23, s29, v227
    v_fmac_f32_dpp v8, v25, v16 row_newbcast:8 row_mask:0xf bank_mask:0xf
    v_fmac_f32_dpp v9, v25, v17 row_newbcast:8 row_mask:0xf bank_mask:0xf
    v_fmac_f32_dpp v10, v25, v18 row_newbcast:8 row_mask:0xf bank_mask:0xf
    v_fmac_f32_dpp v11, v25, v19 row_newbcast:8 row_mask:0xf bank_mask:0xf
    v_fmac_f32_dpp v12, v25, v20 row_newbcast:8 row_mask:0xf bank_mask:0xf
    v_fmac_f32_dpp v13, v25, v21 row_newbcast:8 row_mask:0xf bank_mask:0xf
    v_fmac_f32_dpp v14, v25, v22 row_newbcast:8 row_mask:0xf bank_mask:0xf
    v_fmac_f32_dpp v15, v25, v23 row_newbcast:8 row_mask:0xf bank_mask:0xf
    v_lshlrev_b32 v16, 16, v228
    v_and_b32 v17, s29, v228
    v_lshlrev_b32 v18, 16, v229
    v_and_b32 v19, s29, v229
    v_lshlrev_b32 v20, 16, v230
    v_and_b32 v21, s29, v230
    v_lshlrev_b32 v22, 16, v231
    v_and_b32 v23, s29, v231
    v_fmac_f32_dpp v8, v25, v16 row_newbcast:9 row_mask:0xf bank_mask:0xf
    v_fmac_f32_dpp v9, v25, v17 row_newbcast:9 row_mask:0xf bank_mask:0xf
    v_fmac_f32_dpp v10, v25, v18 row_newbcast:9 row_mask:0xf bank_mask:0xf
    v_fmac_f32_dpp v11, v25, v19 row_newbcast:9 row_mask:0xf bank_mask:0xf
    v_fmac_f32_dpp v12, v25, v20 row_newbcast:9 row_mask:0xf bank_mask:0xf
    v_fmac_f32_dpp v13, v25, v21 row_newbcast:9 row_mask:0xf bank_mask:0xf
    v_fmac_f32_dpp v14, v25, v22 row_newbcast:9 row_mask:0xf bank_mask:0xf
    v_fmac_f32_dpp v15, v25, v23 row_newbcast:9 row_mask:0xf bank_mask:0xf
    v_lshlrev_b32 v16, 16, v232
    v_and_b32 v17, s29, v232
    v_lshlrev_b32 v18, 16, v233
    v_and_b32 v19, s29, v233
    v_lshlrev_b32 v20, 16, v234
    v_and_b32 v21, s29, v234
    v_lshlrev_b32 v22, 16, v235
    v_and_b32 v23, s29, v235
    v_fmac_f32_dpp v8, v25, v16 row_newbcast:10 row_mask:0xf bank_mask:0xf
    v_fmac_f32_dpp v9, v25, v17 row_newbcast:10 row_mask:0xf bank_mask:0xf
    v_fmac_f32_dpp v10, v25, v18 row_newbcast:10 row_mask:0xf bank_mask:0xf
    v_fmac_f32_dpp v11, v25, v19 row_newbcast:10 row_mask:0xf bank_mask:0xf
    v_fmac_f32_dpp v12, v25, v20 row_newbcast:10 row_mask:0xf bank_mask:0xf
    v_fmac_f32_dpp v13, v25, v21 row_newbcast:10 row_mask:0xf bank_mask:0xf
    v_fmac_f32_dpp v14, v25, v22 row_newbcast:10 row_mask:0xf bank_mask:0xf
    v_fmac_f32_dpp v15, v25, v23 row_newbcast:10 row_mask:0xf bank_mask:0xf
    v_lshlrev_b32 v16, 16, v236
    v_and_b32 v17, s29, v236
    v_lshlrev_b32 v18, 16, v237
    v_and_b32 v19, s29, v237
    v_lshlrev_b32 v20, 16, v238
    v_and_b32 v21, s29, v238
    v_lshlrev_b32 v22, 16, v239
    v_and_b32 v23, s29, v239
    v_fmac_f32_dpp v8, v25, v16 row_newbcast:11 row_mask:0xf bank_mask:0xf
    v_fmac_f32_dpp v9, v25, v17 row_newbcast:11 row_mask:0xf bank_mask:0xf
    v_fmac_f32_dpp v10, v25, v18 row_newbcast:11 row_mask:0xf bank_mask:0xf
    v_fmac_f32_dpp v11, v25, v19 row_newbcast:11 row_mask:0xf bank_mask:0xf
    v_fmac_f32_dpp v12, v25, v20 row_newbcast:11 row_mask:0xf bank_mask:0xf
    v_fmac_f32_dpp v13, v25, v21 row_newbcast:11 row_mask:0xf bank_mask:0xf
    v_fmac_f32_dpp v14, v25, v22 row_newbcast:11 row_mask:0xf bank_mask:0xf
    v_fmac_f32_dpp v15, v25, v23 row_newbcast:11 row_mask:0xf bank_mask:0xf
    v_lshlrev_b32 v16, 16, v240
    v_and_b32 v17, s29, v240
    v_lshlrev_b32 v18, 16, v241
    v_and_b32 v19, s29, v241
    v_lshlrev_b32 v20, 16, v242
    v_and_b32 v21, s29, v242
    v_lshlrev_b32 v22, 16, v243
    v_and_b32 v23, s29, v243
    v_fmac_f32_dpp v8, v25, v16 row_newbcast:12 row_mask:0xf bank_mask:0xf
    v_fmac_f32_dpp v9, v25, v17 row_newbcast:12 row_mask:0xf bank_mask:0xf
    v_fmac_f32_dpp v10, v25, v18 row_newbcast:12 row_mask:0xf bank_mask:0xf
    v_fmac_f32_dpp v11, v25, v19 row_newbcast:12 row_mask:0xf bank_mask:0xf
    v_fmac_f32_dpp v12, v25, v20 row_newbcast:12 row_mask:0xf bank_mask:0xf
    v_fmac_f32_dpp v13, v25, v21 row_newbcast:12 row_mask:0xf bank_mask:0xf
    v_fmac_f32_dpp v14, v25, v22 row_newbcast:12 row_mask:0xf bank_mask:0xf
    v_fmac_f32_dpp v15, v25, v23 row_newbcast:12 row_mask:0xf bank_mask:0xf
    v_lshlrev_b32 v16, 16, v244
    v_and_b32 v17, s29, v244
    v_lshlrev_b32 v18, 16, v245
    v_and_b32 v19, s29, v245
    v_lshlrev_b32 v20, 16, v246
    v_and_b32 v21, s29, v246
    v_lshlrev_b32 v22, 16, v247
    v_and_b32 v23, s29, v247
    v_fmac_f32_dpp v8, v25, v16 row_newbcast:13 row_mask:0xf bank_mask:0xf
    v_fmac_f32_dpp v9, v25, v17 row_newbcast:13 row_mask:0xf bank_mask:0xf
    v_fmac_f32_dpp v10, v25, v18 row_newbcast:13 row_mask:0xf bank_mask:0xf
    v_fmac_f32_dpp v11, v25, v19 row_newbcast:13 row_mask:0xf bank_mask:0xf
    v_fmac_f32_dpp v12, v25, v20 row_newbcast:13 row_mask:0xf bank_mask:0xf
    v_fmac_f32_dpp v13, v25, v21 row_newbcast:13 row_mask:0xf bank_mask:0xf
    v_fmac_f32_dpp v14, v25, v22 row_newbcast:13 row_mask:0xf bank_mask:0xf
    v_fmac_f32_dpp v15, v25, v23 row_newbcast:13 row_mask:0xf bank_mask:0xf
    v_lshlrev_b32 v16, 16, v248
    v_and_b32 v17, s29, v248
    v_lshlrev_b32 v18, 16, v249
    v_and_b32 v19, s29, v249
    v_lshlrev_b32 v20, 16, v250
    v_and_b32 v21, s29, v250
    v_lshlrev_b32 v22, 16, v251
    v_and_b32 v23, s29, v251
    v_fmac_f32_dpp v8, v25, v16 row_newbcast:14 row_mask:0xf bank_mask:0xf
    v_fmac_f32_dpp v9, v25, v17 row_newbcast:14 row_mask:0xf bank_mask:0xf
    v_fmac_f32_dpp v10, v25, v18 row_newbcast:14 row_mask:0xf bank_mask:0xf
    v_fmac_f32_dpp v11, v25, v19 row_newbcast:14 row_mask:0xf bank_mask:0xf
    v_fmac_f32_dpp v12, v25, v20 row_newbcast:14 row_mask:0xf bank_mask:0xf
    v_fmac_f32_dpp v13, v25, v21 row_newbcast:14 row_mask:0xf bank_mask:0xf
    v_fmac_f32_dpp v14, v25, v22 row_newbcast:14 row_mask:0xf bank_mask:0xf
    v_fmac_f32_dpp v15, v25, v23 row_newbcast:14 row_mask:0xf bank_mask:0xf
    v_lshlrev_b32 v16, 16, v252
    v_and_b32 v17, s29, v252
    v_lshlrev_b32 v18, 16, v253
    v_and_b32 v19, s29, v253
    v_lshlrev_b32 v20, 16, v254
    v_and_b32 v21, s29, v254
    v_lshlrev_b32 v22, 16, v255
    v_and_b32 v23, s29, v255
    v_fmac_f32_dpp v8, v25, v16 row_newbcast:15 row_mask:0xf bank_mask:0xf
    v_fmac_f32_dpp v9, v25, v17 row_newbcast:15 row_mask:0xf bank_mask:0xf
    v_fmac_f32_dpp v10, v25, v18 row_newbcast:15 row_mask:0xf bank_mask:0xf
    v_fmac_f32_dpp v11, v25, v19 row_newbcast:15 row_mask:0xf bank_mask:0xf
    v_fmac_f32_dpp v12, v25, v20 row_newbcast:15 row_mask:0xf bank_mask:0xf
    v_fmac_f32_dpp v13, v25, v21 row_newbcast:15 row_mask:0xf bank_mask:0xf
    v_fmac_f32_dpp v14, v25, v22 row_newbcast:15 row_mask:0xf bank_mask:0xf
    v_fmac_f32_dpp v15, v25, v23 row_newbcast:15 row_mask:0xf bank_mask:0xf
    v_mov_b32 v16, v8
    v_mov_b32 v17, v9
    v_mov_b32 v18, v10
    v_mov_b32 v19, v11
    v_mov_b32 v20, v12
    v_mov_b32 v21, v13
    v_mov_b32 v22, v14
    v_mov_b32 v23, v15
    s_nop 1
    v_permlane32_swap_b32 v8, v16
    v_permlane32_swap_b32 v9, v17
    v_permlane32_swap_b32 v10, v18
    v_permlane32_swap_b32 v11, v19
    v_permlane32_swap_b32 v12, v20
    v_permlane32_swap_b32 v13, v21
    v_permlane32_swap_b32 v14, v22
    v_permlane32_swap_b32 v15, v23
    s_nop 0
    v_add_f32 v8, v8, v16
    v_add_f32 v9, v9, v17
    v_add_f32 v10, v10, v18
    v_add_f32 v11, v11, v19
    v_add_f32 v12, v12, v20
    v_add_f32 v13, v13, v21
    v_add_f32 v14, v14, v22
    v_add_f32 v15, v15, v23
    v_mov_b32 v16, v8
    v_mov_b32 v17, v9
    v_mov_b32 v18, v10
    v_mov_b32 v19, v11
    v_mov_b32 v20, v12
    v_mov_b32 v21, v13
    v_mov_b32 v22, v14
    v_mov_b32 v23, v15
    s_nop 1
    v_permlane16_swap_b32 v8, v16
    v_permlane16_swap_b32 v9, v17
    v_permlane16_swap_b32 v10, v18
    v_permlane16_swap_b32 v11, v19
    v_permlane16_swap_b32 v12, v20
    v_permlane16_swap_b32 v13, v21
    v_permlane16_swap_b32 v14, v22
    v_permlane16_swap_b32 v15, v23
    s_nop 0
    v_add_f32 v8, v8, v16
    v_add_f32 v9, v9, v17
    v_add_f32 v10, v10, v18
    v_add_f32 v11, v11, v19
    v_add_f32 v12, v12, v20
    v_add_f32 v13, v13, v21
    v_add_f32 v14, v14, v22
    v_add_f32 v15, v15, v23
    v_and_b32 v29, 15, v1
    v_lshlrev_b32 v28, 5, v29
    s_lshl_b32 s36, s19, 9
    v_add_u32 v30, s36, v28
    ds_write_b128 v30, v[8:11] offset:0
    ds_write_b128 v30, v[12:15] offset:16
    s_cmp_eq_u32 s41, 0
    s_cbranch_scc1 L_noduty0
    s_waitcnt vmcnt(32)
    v_lshlrev_b32 v48, 16, v40
    v_and_b32 v49, 0xffff0000, v40
    v_lshlrev_b32 v50, 16, v41
    v_and_b32 v51, 0xffff0000, v41
    v_lshlrev_b32 v52, 16, v42
    v_and_b32 v53, 0xffff0000, v42
    v_lshlrev_b32 v54, 16, v43
    v_and_b32 v55, 0xffff0000, v43
    v_add_f32 v56, v48, v49
    v_add_f32 v56, v56, v50
    v_add_f32 v56, v56, v51
    v_add_f32 v56, v56, v52
    v_add_f32 v56, v56, v53
    v_add_f32 v56, v56, v54
    v_add_f32 v56, v56, v55
    s_nop 1
    v_add_f32_dpp v56, v56, v56 quad_perm:[1,0,3,2] row_mask:0xf bank_mask:0xf
    s_nop 1
    v_add_f32_dpp v56, v56, v56 quad_perm:[2,3,0,1] row_mask:0xf bank_mask:0xf
    s_nop 1
    v_add_f32_dpp v56, v56, v56 row_half_mirror row_mask:0xf bank_mask:0xf
    s_nop 1
    v_add_f32_dpp v56, v56, v56 row_mirror row_mask:0xf bank_mask:0xf
    s_nop 0
    v_readlane_b32 s30, v56, 0
    v_readlane_b32 s31, v56, 16
    v_readlane_b32 s32, v56, 32
    v_readlane_b32 s33, v56, 48
    s_nop 1
    v_mov_b32 v56, s30
    v_add_f32 v56, s31, v56
    v_add_f32 v56, s32, v56
    v_add_f32 v56, s33, v56
    v_mul_f32 v56, 0x3b000000, v56
    v_sub_f32 v48, v48, v56
    v_sub_f32 v49, v49, v56
    v_sub_f32 v50, v50, v56
    v_sub_f32 v51, v51, v56
    v_sub_f32 v52, v52, v56
    v_sub_f32 v53, v53, v56
    v_sub_f32 v54, v54, v56
    v_sub_f32 v55, v55, v56
    v_mul_f32 v57, v48, v48
    v_fmac_f32 v57, v49, v49
    v_fmac_f32 v57, v50, v50
    v_fmac_f32 v57, v51, v51
    v_fmac_f32 v57, v52, v52
    v_fmac_f32 v57, v53, v53
    v_fmac_f32 v57, v54, v54
    v_fmac_f32 v57, v55, v55
    s_nop 1
    v_add_f32_dpp v57, v57, v57 quad_perm:[1,0,3,2] row_mask:0xf bank_mask:0xf
    s_nop 1
    v_add_f32_dpp v57, v57, v57 quad_perm:[2,3,0,1] row_mask:0xf bank_mask:0xf
    s_nop 1
    v_add_f32_dpp v57, v57, v57 row_half_mirror row_mask:0xf bank_mask:0xf
    s_nop 1
    v_add_f32_dpp v57, v57, v57 row_mirror row_mask:0xf bank_mask:0xf
    s_nop 0
    v_readlane_b32 s30, v57, 0
    v_readlane_b32 s31, v57, 16
    v_readlane_b32 s32, v57, 32
    v_readlane_b32 s33, v57, 48
    s_nop 1
    v_mov_b32 v57, s30
    v_add_f32 v57, s31, v57
    v_add_f32 v57, s32, v57
    v_add_f32 v57, s33, v57
    v_mul_f32 v57, 0x3b000000, v57
    v_cvt_pk_bf16_f32 v58, v56, v56
    v_and_b32 v58, 0xffff0000, v58
    v_cvt_pk_bf16_f32 v57, v57, v57
    v_and_b32 v57, 0xffff0000, v57
    v_add_f32 v57, 0x3727c5ac, v57
    v_cvt_pk_bf16_f32 v57, v57, v57
    v_and_b32 v57, 0xffff0000, v57
    v_sqrt_f32 v57, v57
    s_nop 0
    v_cvt_pk_bf16_f32 v59, v57, v57
    v_and_b32 v59, 0xffff0000, v59
    v_rcp_f32 v60, v59
    s_nop 0
    v_lshlrev_b32 v56, 16, v32
    v_sub_f32 v56, v56, v58
    v_cvt_pk_bf16_f32 v56, v56, v56
    v_and_b32 v56, 0xffff0000, v56
    v_mul_f32 v57, v56, v60
    v_fma_f32 v56, -v57, v59, v56
    v_fmac_f32 v57, v56, v60
    v_cvt_pk_bf16_f32 v32, v57, v57
    v_and_b32 v32, 0xffff0000, v32
    v_lshlrev_b32 v56, 16, v33
    v_sub_f32 v56, v56, v58
    v_cvt_pk_bf16_f32 v56, v56, v56
    v_and_b32 v56, 0xffff0000, v56
    v_mul_f32 v57, v56, v60
    v_fma_f32 v56, -v57, v59, v56
    v_fmac_f32 v57, v56, v60
    v_cvt_pk_bf16_f32 v33, v57, v57
    v_and_b32 v33, 0xffff0000, v33
    v_lshlrev_b32 v56, 16, v34
    v_sub_f32 v56, v56, v58
    v_cvt_pk_bf16_f32 v56, v56, v56
    v_and_b32 v56, 0xffff0000, v56
    v_mul_f32 v57, v56, v60
    v_fma_f32 v56, -v57, v59, v56
    v_fmac_f32 v57, v56, v60
    v_cvt_pk_bf16_f32 v34, v57, v57
    v_and_b32 v34, 0xffff0000, v34
    v_lshlrev_b32 v56, 16, v35
    v_sub_f32 v56, v56, v58
    v_cvt_pk_bf16_f32 v56, v56, v56
    v_and_b32 v56, 0xffff0000, v56
    v_mul_f32 v57, v56, v60
    v_fma_f32 v56, -v57, v59, v56
    v_fmac_f32 v57, v56, v60
    v_cvt_pk_bf16_f32 v35, v57, v57
    v_and_b32 v35, 0xffff0000, v35
    v_lshlrev_b32 v48, 16, v44
    v_and_b32 v49, 0xffff0000, v44
    v_lshlrev_b32 v50, 16, v45
    v_and_b32 v51, 0xffff0000, v45
    v_lshlrev_b32 v52, 16, v46
    v_and_b32 v53, 0xffff0000, v46
    v_lshlrev_b32 v54, 16, v47
    v_and_b32 v55, 0xffff0000, v47
    v_add_f32 v56, v48, v49
    v_add_f32 v56, v56, v50
    v_add_f32 v56, v56, v51
    v_add_f32 v56, v56, v52
    v_add_f32 v56, v56, v53
    v_add_f32 v56, v56, v54
    v_add_f32 v56, v56, v55
    s_nop 1
    v_add_f32_dpp v56, v56, v56 quad_perm:[1,0,3,2] row_mask:0xf bank_mask:0xf
    s_nop 1
    v_add_f32_dpp v56, v56, v56 quad_perm:[2,3,0,1] row_mask:0xf bank_mask:0xf
    s_nop 1
    v_add_f32_dpp v56, v56, v56 row_half_mirror row_mask:0xf bank_mask:0xf
    s_nop 1
    v_add_f32_dpp v56, v56, v56 row_mirror row_mask:0xf bank_mask:0xf
    s_nop 0
    v_readlane_b32 s30, v56, 0
    v_readlane_b32 s31, v56, 16
    v_readlane_b32 s32, v56, 32
    v_readlane_b32 s33, v56, 48
    s_nop 1
    v_mov_b32 v56, s30
    v_add_f32 v56, s31, v56
    v_add_f32 v56, s32, v56
    v_add_f32 v56, s33, v56
    v_mul_f32 v56, 0x3b000000, v56
    v_sub_f32 v48, v48, v56
    v_sub_f32 v49, v49, v56
    v_sub_f32 v50, v50, v56
    v_sub_f32 v51, v51, v56
    v_sub_f32 v52, v52, v56
    v_sub_f32 v53, v53, v56
    v_sub_f32 v54, v54, v56
    v_sub_f32 v55, v55, v56
    v_mul_f32 v57, v48, v48
    v_fmac_f32 v57, v49, v49
    v_fmac_f32 v57, v50, v50
    v_fmac_f32 v57, v51, v51
    v_fmac_f32 v57, v52, v52
    v_fmac_f32 v57, v53, v53
    v_fmac_f32 v57, v54, v54
    v_fmac_f32 v57, v55, v55
    s_nop 1
    v_add_f32_dpp v57, v57, v57 quad_perm:[1,0,3,2] row_mask:0xf bank_mask:0xf
    s_nop 1
    v_add_f32_dpp v57, v57, v57 quad_perm:[2,3,0,1] row_mask:0xf bank_mask:0xf
    s_nop 1
    v_add_f32_dpp v57, v57, v57 row_half_mirror row_mask:0xf bank_mask:0xf
    s_nop 1
    v_add_f32_dpp v57, v57, v57 row_mirror row_mask:0xf bank_mask:0xf
    s_nop 0
    v_readlane_b32 s30, v57, 0
    v_readlane_b32 s31, v57, 16
    v_readlane_b32 s32, v57, 32
    v_readlane_b32 s33, v57, 48
    s_nop 1
    v_mov_b32 v57, s30
    v_add_f32 v57, s31, v57
    v_add_f32 v57, s32, v57
    v_add_f32 v57, s33, v57
    v_mul_f32 v57, 0x3b000000, v57
    v_cvt_pk_bf16_f32 v58, v56, v56
    v_and_b32 v58, 0xffff0000, v58
    v_cvt_pk_bf16_f32 v57, v57, v57
    v_and_b32 v57, 0xffff0000, v57
    v_add_f32 v57, 0x3727c5ac, v57
    v_cvt_pk_bf16_f32 v57, v57, v57
    v_and_b32 v57, 0xffff0000, v57
    v_sqrt_f32 v57, v57
    s_nop 0
    v_cvt_pk_bf16_f32 v59, v57, v57
    v_and_b32 v59, 0xffff0000, v59
    v_rcp_f32 v60, v59
    s_nop 0
    v_lshlrev_b32 v56, 16, v36
    v_sub_f32 v56, v56, v58
    v_cvt_pk_bf16_f32 v56, v56, v56
    v_and_b32 v56, 0xffff0000, v56
    v_mul_f32 v57, v56, v60
    v_fma_f32 v56, -v57, v59, v56
    v_fmac_f32 v57, v56, v60
    v_cvt_pk_bf16_f32 v36, v57, v57
    v_and_b32 v36, 0xffff0000, v36
    v_lshlrev_b32 v56, 16, v37
    v_sub_f32 v56, v56, v58
    v_cvt_pk_bf16_f32 v56, v56, v56
    v_and_b32 v56, 0xffff0000, v56
    v_mul_f32 v57, v56, v60
    v_fma_f32 v56, -v57, v59, v56
    v_fmac_f32 v57, v56, v60
    v_cvt_pk_bf16_f32 v37, v57, v57
    v_and_b32 v37, 0xffff0000, v37
    v_lshlrev_b32 v56, 16, v38
    v_sub_f32 v56, v56, v58
    v_cvt_pk_bf16_f32 v56, v56, v56
    v_and_b32 v56, 0xffff0000, v56
    v_mul_f32 v57, v56, v60
    v_fma_f32 v56, -v57, v59, v56
    v_fmac_f32 v57, v56, v60
    v_cvt_pk_bf16_f32 v38, v57, v57
    v_and_b32 v38, 0xffff0000, v38
    v_lshlrev_b32 v56, 16, v39
    v_sub_f32 v56, v56, v58
    v_cvt_pk_bf16_f32 v56, v56, v56
    v_and_b32 v56, 0xffff0000, v56
    v_mul_f32 v57, v56, v60
    v_fma_f32 v56, -v57, v59, v56
    v_fmac_f32 v57, v56, v60
    v_cvt_pk_bf16_f32 v39, v57, v57
    v_and_b32 v39, 0xffff0000, v39
L_noduty0:
    s_waitcnt lgkmcnt(0)
    s_barrier
    ds_read_b128 v[192:195], v28 offset:0
    ds_read_b128 v[196:199], v28 offset:16
    ds_read_b128 v[200:203], v28 offset:512
    ds_read_b128 v[204:207], v28 offset:528
    ds_read_b128 v[208:211], v28 offset:1024
    ds_read_b128 v[212:215], v28 offset:1040
    ds_read_b128 v[216:219], v28 offset:1536
    ds_read_b128 v[220:223], v28 offset:1552
    ds_read_b128 v[224:227], v28 offset:2048
    ds_read_b128 v[228:231], v28 offset:2064
    ds_read_b128 v[232:235], v28 offset:2560
    ds_read_b128 v[236:239], v28 offset:2576
    ds_read_b128 v[240:243], v28 offset:3072
    ds_read_b128 v[244:247], v28 offset:3088
    ds_read_b128 v[248:251], v28 offset:3584
    ds_read_b128 v[252:255], v28 offset:3600
    s_waitcnt lgkmcnt(0)
    v_add_f32 v8, v192, v200
    v_add_f32 v9, v193, v201
    v_add_f32 v10, v194, v202
    v_add_f32 v11, v195, v203
    v_add_f32 v12, v196, v204
    v_add_f32 v13, v197, v205
    v_add_f32 v14, v198, v206
    v_add_f32 v15, v199, v207
    v_add_f32 v8, v8, v208
    v_add_f32 v9, v9, v209
    v_add_f32 v10, v10, v210
    v_add_f32 v11, v11, v211
    v_add_f32 v12, v12, v212
    v_add_f32 v13, v13, v213
    v_add_f32 v14, v14, v214
    v_add_f32 v15, v15, v215
    v_add_f32 v8, v8, v216
    v_add_f32 v9, v9, v217
    v_add_f32 v10, v10, v218
    v_add_f32 v11, v11, v219
    v_add_f32 v12, v12, v220
    v_add_f32 v13, v13, v221
    v_add_f32 v14, v14, v222
    v_add_f32 v15, v15, v223
    v_add_f32 v8, v8, v224
    v_add_f32 v9, v9, v225
    v_add_f32 v10, v10, v226
    v_add_f32 v11, v11, v227
    v_add_f32 v12, v12, v228
    v_add_f32 v13, v13, v229
    v_add_f32 v14, v14, v230
    v_add_f32 v15, v15, v231
    v_add_f32 v8, v8, v232
    v_add_f32 v9, v9, v233
    v_add_f32 v10, v10, v234
    v_add_f32 v11, v11, v235
    v_add_f32 v12, v12, v236
    v_add_f32 v13, v13, v237
    v_add_f32 v14, v14, v238
    v_add_f32 v15, v15, v239
    v_add_f32 v8, v8, v240
    v_add_f32 v9, v9, v241
    v_add_f32 v10, v10, v242
    v_add_f32 v11, v11, v243
    v_add_f32 v12, v12, v244
    v_add_f32 v13, v13, v245
    v_add_f32 v14, v14, v246
    v_add_f32 v15, v15, v247
    v_add_f32 v8, v8, v248
    v_add_f32 v9, v9, v249
    v_add_f32 v10, v10, v250
    v_add_f32 v11, v11, v251
    v_add_f32 v12, v12, v252
    v_add_f32 v13, v13, v253
    v_add_f32 v14, v14, v254
    v_add_f32 v15, v15, v255
    v_cvt_pk_bf16_f32 v4, v8, v9
    v_cvt_pk_bf16_f32 v5, v10, v11
    v_cvt_pk_bf16_f32 v6, v12, v13
    v_cvt_pk_bf16_f32 v7, v14, v15
    s_cmp_eq_u32 s41, 0
    s_cbranch_scc1 L_noduty2
    s_lshl_b32 s38, s42, 6
    s_lshl_b32 s39, s42, 15
    s_lshl_b32 s36, s19, 12
    s_add_u32 s39, s39, s36
    s_add_u32 s44, s44, s38
    s_addc_u32 s45, s45, 0
    s_add_u32 s46, s46, s38
    s_addc_u32 s47, s47, 0
    s_add_u32 s48, s48, s39
    s_addc_u32 s49, s49, 0
    global_load_dwordx4 v[192:195], v63, s[44:45]
    global_load_dwordx4 v[208:211], v63, s[46:47]
    s_add_u32 s44, s44, 44032
    s_addc_u32 s45, s45, 0
    s_add_u32 s46, s46, 44032
    s_addc_u32 s47, s47, 0
    global_load_dwordx4 v[196:199], v63, s[44:45]
    global_load_dwordx4 v[212:215], v63, s[46:47]
    s_add_u32 s44, s44, 44032
    s_addc_u32 s45, s45, 0
    s_add_u32 s46, s46, 44032
    s_addc_u32 s47, s47, 0
    global_load_dwordx4 v[200:203], v63, s[44:45]
    global_load_dwordx4 v[216:219], v63, s[46:47]
    s_add_u32 s44, s44, 44032
    s_addc_u32 s45, s45, 0
    s_add_u32 s46, s46, 44032
    s_addc_u32 s47, s47, 0
    global_load_dwordx4 v[204:207], v63, s[44:45]
    global_load_dwordx4 v[220:223], v63, s[46:47]
    global_load_dwordx4 v[224:227], v2, s[48:49] offset:0
    global_load_dwordx4 v[228:231], v2, s[48:49] offset:1024
    global_load_dwordx4 v[232:235], v2, s[48:49] offset:2048
    global_load_dwordx4 v[236:239], v2, s[48:49] offset:3072
    global_load_dword v240, v2, s[4:5]
    global_load_dword v241, v2, s[4:5]
    global_load_dword v242, v2, s[4:5]
    global_load_dword v243, v2, s[4:5]
    s_branch L_join2
L_noduty2:
    global_load_dwordx4 v[192:195], v3, s[26:27] offset:-4096
    global_load_dwordx4 v[196:199], v3, s[26:27] offset:-3072
    global_load_dwordx4 v[200:203], v3, s[26:27] offset:-2048
    global_load_dwordx4 v[204:207], v3, s[26:27] offset:-1024
    global_load_dwordx4 v[208:211], v3, s[26:27] offset:0
    global_load_dwordx4 v[212:215], v3, s[26:27] offset:1024
    global_load_dwordx4 v[216:219], v3, s[26:27] offset:2048
    global_load_dwordx4 v[220:223], v3, s[26:27] offset:3072
    s_add_u32 s26, s26, 65536
    s_addc_u32 s27, s27, 0
    global_load_dwordx4 v[224:227], v3, s[26:27] offset:-4096
    global_load_dwordx4 v[228:231], v3, s[26:27] offset:-3072
    global_load_dwordx4 v[232:235], v3, s[26:27] offset:-2048
    global_load_dwordx4 v[236:239], v3, s[26:27] offset:-1024
    global_load_dwordx4 v[240:243], v3, s[26:27] offset:0
    global_load_dwordx4 v[244:247], v3, s[26:27] offset:1024
    global_load_dwordx4 v[248:251], v3, s[26:27] offset:2048
    global_load_dwordx4 v[252:255], v3, s[26:27] offset:3072
L_join2:
    v_mov_b32 v8, 0
    v_mov_b32 v9, 0
    v_mov_b32 v10, 0
    v_mov_b32 v11, 0
    v_mov_b32 v12, 0
    v_mov_b32 v13, 0
    v_mov_b32 v14, 0
    v_mov_b32 v15, 0
    v_mov_b32 v24, 0xff800000
    v_mov_b32 v25, 0xff800000
    v_mov_b32 v26, 0
    s_waitcnt vmcnt(40)
    v_dot2_f32_bf16 v16, v64, v4, 0
    v_dot2_f32_bf16 v17, v68, v4, 0
    v_dot2_f32_bf16 v18, v72, v4, 0
    v_dot2_f32_bf16 v19, v76, v4, 0
    v_dot2_f32_bf16 v20, v80, v4, 0
    v_dot2_f32_bf16 v21, v84, v4, 0
    v_dot2_f32_bf16 v22, v88, v4, 0
    v_dot2_f32_bf16 v23, v92, v4, 0
    v_dot2_f32_bf16 v16, v65, v5, v16
    v_dot2_f32_bf16 v17, v69, v5, v17
    v_dot2_f32_bf16 v18, v73, v5, v18
    v_dot2_f32_bf16 v19, v77, v5, v19
    v_dot2_f32_bf16 v20, v81, v5, v20
    v_dot2_f32_bf16 v21, v85, v5, v21
    v_dot2_f32_bf16 v22, v89, v5, v22
    v_dot2_f32_bf16 v23, v93, v5, v23
    v_dot2_f32_bf16 v16, v66, v6, v16
    v_dot2_f32_bf16 v17, v70, v6, v17
    v_dot2_f32_bf16 v18, v74, v6, v18
    v_dot2_f32_bf16 v19, v78, v6, v19
    v_dot2_f32_bf16 v20, v82, v6, v20
    v_dot2_f32_bf16 v21, v86, v6, v21
    v_dot2_f32_bf16 v22, v90, v6, v22
    v_dot2_f32_bf16 v23, v94, v6, v23
    v_dot2_f32_bf16 v16, v67, v7, v16
    v_dot2_f32_bf16 v17, v71, v7, v17
    v_dot2_f32_bf16 v18, v75, v7, v18
    v_dot2_f32_bf16 v19, v79, v7, v19
    v_dot2_f32_bf16 v20, v83, v7, v20
    v_dot2_f32_bf16 v21, v87, v7, v21
    v_dot2_f32_bf16 v22, v91, v7, v22
    v_dot2_f32_bf16 v23, v95, v7, v23
    global_load_dwordx4 v[64:67], v3, s[20:21] offset:-4096 nt
    global_load_dwordx4 v[68:71], v3, s[20:21] offset:-3072 nt
    global_load_dwordx4 v[72:75], v3, s[20:21] offset:-2048 nt
    global_load_dwordx4 v[76:79], v3, s[20:21] offset:-1024 nt
    global_load_dwordx4 v[80:83], v3, s[20:21] offset:0 nt
    global_load_dwordx4 v[84:87], v3, s[20:21] offset:1024 nt
    global_load_dwordx4 v[88:91], v3, s[20:21] offset:2048 nt
    global_load_dwordx4 v[92:95], v3, s[20:21] offset:3072 nt
    s_add_u32 s20, s20, 65536
    s_addc_u32 s21, s21, 0
    v_add_f32_dpp v16, v16, v16 quad_perm:[1,0,3,2] row_mask:0xf bank_mask:0xf
    v_add_f32_dpp v17, v17, v17 quad_perm:[1,0,3,2] row_mask:0xf bank_mask:0xf
    v_add_f32_dpp v18, v18, v18 quad_perm:[1,0,3,2] row_mask:0xf bank_mask:0xf
    v_add_f32_dpp v19, v19, v19 quad_perm:[1,0,3,2] row_mask:0xf bank_mask:0xf
    v_add_f32_dpp v20, v20, v20 quad_perm:[1,0,3,2] row_mask:0xf bank_mask:0xf
    v_add_f32_dpp v21, v21, v21 quad_perm:[1,0,3,2] row_mask:0xf bank_mask:0xf
    v_add_f32_dpp v22, v22, v22 quad_perm:[1,0,3,2] row_mask:0xf bank_mask:0xf
    v_add_f32_dpp v23, v23, v23 quad_perm:[1,0,3,2] row_mask:0xf bank_mask:0xf
    v_add_f32_dpp v16, v16, v16 quad_perm:[2,3,0,1] row_mask:0xf bank_mask:0xf
    v_add_f32_dpp v17, v17, v17 quad_perm:[2,3,0,1] row_mask:0xf bank_mask:0xf
    v_add_f32_dpp v18, v18, v18 quad_perm:[2,3,0,1] row_mask:0xf bank_mask:0xf
    v_add_f32_dpp v19, v19, v19 quad_perm:[2,3,0,1] row_mask:0xf bank_mask:0xf
    v_add_f32_dpp v20, v20, v20 quad_perm:[2,3,0,1] row_mask:0xf bank_mask:0xf
    v_add_f32_dpp v21, v21, v21 quad_perm:[2,3,0,1] row_mask:0xf bank_mask:0xf
    v_add_f32_dpp v22, v22, v22 quad_perm:[2,3,0,1] row_mask:0xf bank_mask:0xf
    v_add_f32_dpp v23, v23, v23 quad_perm:[2,3,0,1] row_mask:0xf bank_mask:0xf
    v_add_f32_dpp v16, v16, v16 row_half_mirror row_mask:0xf bank_mask:0xf
    v_add_f32_dpp v17, v17, v17 row_half_mirror row_mask:0xf bank_mask:0xf
    v_add_f32_dpp v18, v18, v18 row_half_mirror row_mask:0xf bank_mask:0xf
    v_add_f32_dpp v19, v19, v19 row_half_mirror row_mask:0xf bank_mask:0xf
    v_add_f32_dpp v20, v20, v20 row_half_mirror row_mask:0xf bank_mask:0xf
    v_add_f32_dpp v21, v21, v21 row_half_mirror row_mask:0xf bank_mask:0xf
    v_add_f32_dpp v22, v22, v22 row_half_mirror row_mask:0xf bank_mask:0xf
    v_add_f32_dpp v23, v23, v23 row_half_mirror row_mask:0xf bank_mask:0xf
    v_add_f32_dpp v16, v16, v16 row_mirror row_mask:0xf bank_mask:0xf
    v_add_f32_dpp v17, v17, v17 row_mirror row_mask:0xf bank_mask:0xf
    v_add_f32_dpp v18, v18, v18 row_mirror row_mask:0xf bank_mask:0xf
    v_add_f32_dpp v19, v19, v19 row_mirror row_mask:0xf bank_mask:0xf
    v_add_f32_dpp v20, v20, v20 row_mirror row_mask:0xf bank_mask:0xf
    v_add_f32_dpp v21, v21, v21 row_mirror row_mask:0xf bank_mask:0xf
    v_add_f32_dpp v22, v22, v22 row_mirror row_mask:0xf bank_mask:0xf
    v_add_f32_dpp v23, v23, v23 row_mirror row_mask:0xf bank_mask:0xf
    v_max3_f32 v27, v16, v17, v18
    v_max3_f32 v27, v27, v19, v20
    v_max3_f32 v27, v27, v21, v22
    v_max3_f32 v24, v27, v23, v24
    v_mul_f32 v28, s28, v24
    v_sub_f32 v27, v25, v28
    v_exp_f32 v27, v27
    v_mov_b32 v25, v28
    v_fma_f32 v16, v16, s28, -v28
    v_fma_f32 v17, v17, s28, -v28
    v_fma_f32 v18, v18, s28, -v28
    v_fma_f32 v19, v19, s28, -v28
    v_fma_f32 v20, v20, s28, -v28
    v_fma_f32 v21, v21, s28, -v28
    v_fma_f32 v22, v22, s28, -v28
    v_fma_f32 v23, v23, s28, -v28
    v_exp_f32 v16, v16
    v_exp_f32 v17, v17
    v_exp_f32 v18, v18
    v_exp_f32 v19, v19
    v_exp_f32 v20, v20
    v_exp_f32 v21, v21
    v_exp_f32 v22, v22
    v_exp_f32 v23, v23
    v_mul_f32 v26, v26, v27
    v_mul_f32 v8, v8, v27
    v_mul_f32 v9, v9, v27
    v_mul_f32 v10, v10, v27
    v_mul_f32 v11, v11, v27
    v_mul_f32 v12, v12, v27
    v_mul_f32 v13, v13, v27
    v_mul_f32 v14, v14, v27
    v_mul_f32 v15, v15, v27
    v_add_f32 v26, v26, v16
    v_add_f32 v26, v26, v17
    v_add_f32 v26, v26, v18
    v_add_f32 v26, v26, v19
    v_add_f32 v26, v26, v20
    v_add_f32 v26, v26, v21
    v_add_f32 v26, v26, v22
    v_add_f32 v26, v26, v23
    s_waitcnt vmcnt(40)
    v_lshlrev_b32 v28, 16, v96
    v_and_b32 v29, s29, v96
    v_lshlrev_b32 v30, 16, v97
    v_and_b32 v31, s29, v97
    v_fmac_f32 v8, v16, v28
    v_fmac_f32 v9, v16, v29
    v_fmac_f32 v10, v16, v30
    v_fmac_f32 v11, v16, v31
    v_lshlrev_b32 v28, 16, v98
    v_and_b32 v29, s29, v98
    v_lshlrev_b32 v30, 16, v99
    v_and_b32 v31, s29, v99
    v_fmac_f32 v12, v16, v28
    v_fmac_f32 v13, v16, v29
    v_fmac_f32 v14, v16, v30
    v_fmac_f32 v15, v16, v31
    v_lshlrev_b32 v28, 16, v100
    v_and_b32 v29, s29, v100
    v_lshlrev_b32 v30, 16, v101
    v_and_b32 v31, s29, v101
    v_fmac_f32 v8, v17, v28
    v_fmac_f32 v9, v17, v29
    v_fmac_f32 v10, v17, v30
    v_fmac_f32 v11, v17, v31
    v_lshlrev_b32 v28, 16, v102
    v_and_b32 v29, s29, v102
    v_lshlrev_b32 v30, 16, v103
    v_and_b32 v31, s29, v103
    v_fmac_f32 v12, v17, v28
    v_fmac_f32 v13, v17, v29
    v_fmac_f32 v14, v17, v30
    v_fmac_f32 v15, v17, v31
    v_lshlrev_b32 v28, 16, v104
    v_and_b32 v29, s29, v104
    v_lshlrev_b32 v30, 16, v105
    v_and_b32 v31, s29, v105
    v_fmac_f32 v8, v18, v28
    v_fmac_f32 v9, v18, v29
    v_fmac_f32 v10, v18, v30
    v_fmac_f32 v11, v18, v31
    v_lshlrev_b32 v28, 16, v106
    v_and_b32 v29, s29, v106
    v_lshlrev_b32 v30, 16, v107
    v_and_b32 v31, s29, v107
    v_fmac_f32 v12, v18, v28
    v_fmac_f32 v13, v18, v29
    v_fmac_f32 v14, v18, v30
    v_fmac_f32 v15, v18, v31
    v_lshlrev_b32 v28, 16, v108
    v_and_b32 v29, s29, v108
    v_lshlrev_b32 v30, 16, v109
    v_and_b32 v31, s29, v109
    v_fmac_f32 v8, v19, v28
    v_fmac_f32 v9, v19, v29
    v_fmac_f32 v10, v19, v30
    v_fmac_f32 v11, v19, v31
    v_lshlrev_b32 v28, 16, v110
    v_and_b32 v29, s29, v110
    v_lshlrev_b32 v30, 16, v111
    v_and_b32 v31, s29, v111
    v_fmac_f32 v12, v19, v28
    v_fmac_f32 v13, v19, v29
    v_fmac_f32 v14, v19, v30
    v_fmac_f32 v15, v19, v31
    v_lshlrev_b32 v28, 16, v112
    v_and_b32 v29, s29, v112
    v_lshlrev_b32 v30, 16, v113
    v_and_b32 v31, s29, v113
    v_fmac_f32 v8, v20, v28
    v_fmac_f32 v9, v20, v29
    v_fmac_f32 v10, v20, v30
    v_fmac_f32 v11, v20, v31
    v_lshlrev_b32 v28, 16, v114
    v_and_b32 v29, s29, v114
    v_lshlrev_b32 v30, 16, v115
    v_and_b32 v31, s29, v115
    v_fmac_f32 v12, v20, v28
    v_fmac_f32 v13, v20, v29
    v_fmac_f32 v14, v20, v30
    v_fmac_f32 v15, v20, v31
    v_lshlrev_b32 v28, 16, v116
    v_and_b32 v29, s29, v116
    v_lshlrev_b32 v30, 16, v117
    v_and_b32 v31, s29, v117
    v_fmac_f32 v8, v21, v28
    v_fmac_f32 v9, v21, v29
    v_fmac_f32 v10, v21, v30
    v_fmac_f32 v11, v21, v31
    v_lshlrev_b32 v28, 16, v118
    v_and_b32 v29, s29, v118
    v_lshlrev_b32 v30, 16, v119
    v_and_b32 v31, s29, v119
    v_fmac_f32 v12, v21, v28
    v_fmac_f32 v13, v21, v29
    v_fmac_f32 v14, v21, v30
    v_fmac_f32 v15, v21, v31
    v_lshlrev_b32 v28, 16, v120
    v_and_b32 v29, s29, v120
    v_lshlrev_b32 v30, 16, v121
    v_and_b32 v31, s29, v121
    v_fmac_f32 v8, v22, v28
    v_fmac_f32 v9, v22, v29
    v_fmac_f32 v10, v22, v30
    v_fmac_f32 v11, v22, v31
    v_lshlrev_b32 v28, 16, v122
    v_and_b32 v29, s29, v122
    v_lshlrev_b32 v30, 16, v123
    v_and_b32 v31, s29, v123
    v_fmac_f32 v12, v22, v28
    v_fmac_f32 v13, v22, v29
    v_fmac_f32 v14, v22, v30
    v_fmac_f32 v15, v22, v31
    v_lshlrev_b32 v28, 16, v124
    v_and_b32 v29, s29, v124
    v_lshlrev_b32 v30, 16, v125
    v_and_b32 v31, s29, v125
    v_fmac_f32 v8, v23, v28
    v_fmac_f32 v9, v23, v29
    v_fmac_f32 v10, v23, v30
    v_fmac_f32 v11, v23, v31
    v_lshlrev_b32 v28, 16, v126
    v_and_b32 v29, s29, v126
    v_lshlrev_b32 v30, 16, v127
    v_and_b32 v31, s29, v127
    v_fmac_f32 v12, v23, v28
    v_fmac_f32 v13, v23, v29
    v_fmac_f32 v14, v23, v30
    v_fmac_f32 v15, v23, v31
    global_load_dwordx4 v[96:99], v3, s[22:23] offset:-4096 nt
    global_load_dwordx4 v[100:103], v3, s[22:23] offset:-3072 nt
    global_load_dwordx4 v[104:107], v3, s[22:23] offset:-2048 nt
    global_load_dwordx4 v[108:111], v3, s[22:23] offset:-1024 nt
    global_load_dwordx4 v[112:115], v3, s[22:23] offset:0 nt
    global_load_dwordx4 v[116:119], v3, s[22:23] offset:1024 nt
    global_load_dwordx4 v[120:123], v3, s[22:23] offset:2048 nt
    global_load_dwordx4 v[124:127], v3, s[22:23] offset:3072 nt
    s_add_u32 s22, s22, 65536
    s_addc_u32 s23, s23, 0
    s_waitcnt vmcnt(40)
    v_dot2_f32_bf16 v16, v128, v4, 0
    v_dot2_f32_bf16 v17, v132, v4, 0
    v_dot2_f32_bf16 v18, v136, v4, 0
    v_dot2_f32_bf16 v19, v140, v4, 0
    v_dot2_f32_bf16 v20, v144, v4, 0
    v_dot2_f32_bf16 v21, v148, v4, 0
    v_dot2_f32_bf16 v22, v152, v4, 0
    v_dot2_f32_bf16 v23, v156, v4, 0
    v_dot2_f32_bf16 v16, v129, v5, v16
    v_dot2_f32_bf16 v17, v133, v5, v17
    v_dot2_f32_bf16 v18, v137, v5, v18
    v_dot2_f32_bf16 v19, v141, v5, v19
    v_dot2_f32_bf16 v20, v145, v5, v20
    v_dot2_f32_bf16 v21, v149, v5, v21
    v_dot2_f32_bf16 v22, v153, v5, v22
    v_dot2_f32_bf16 v23, v157, v5, v23
    v_dot2_f32_bf16 v16, v130, v6, v16
    v_dot2_f32_bf16 v17, v134, v6, v17
    v_dot2_f32_bf16 v18, v138, v6, v18
    v_dot2_f32_bf16 v19, v142, v6, v19
    v_dot2_f32_bf16 v20, v146, v6, v20
    v_dot2_f32_bf16 v21, v150, v6, v21
    v_dot2_f32_bf16 v22, v154, v6, v22
    v_dot2_f32_bf16 v23, v158, v6, v23
    v_dot2_f32_bf16 v16, v131, v7, v16
    v_dot2_f32_bf16 v17, v135, v7, v17
    v_dot2_f32_bf16 v18, v139, v7, v18
    v_dot2_f32_bf16 v19, v143, v7, v19
    v_dot2_f32_bf16 v20, v147, v7, v20
    v_dot2_f32_bf16 v21, v151, v7, v21
    v_dot2_f32_bf16 v22, v155, v7, v22
    v_dot2_f32_bf16 v23, v159, v7, v23
    global_load_dwordx4 v[128:131], v3, s[20:21] offset:-4096 nt
    global_load_dwordx4 v[132:135], v3, s[20:21] offset:-3072 nt
    global_load_dwordx4 v[136:139], v3, s[20:21] offset:-2048 nt
    global_load_dwordx4 v[140:143], v3, s[20:21] offset:-1024 nt
    global_load_dwordx4 v[144:147], v3, s[20:21] offset:0 nt
    global_load_dwordx4 v[148:151], v3, s[20:21] offset:1024 nt
    global_load_dwordx4 v[152:155], v3, s[20:21] offset:2048 nt
    global_load_dwordx4 v[156:159], v3, s[20:21] offset:3072 nt
    s_add_u32 s20, s20, 65536
    s_addc_u32 s21, s21, 0
    v_add_f32_dpp v16, v16, v16 quad_perm:[1,0,3,2] row_mask:0xf bank_mask:0xf
    v_add_f32_dpp v17, v17, v17 quad_perm:[1,0,3,2] row_mask:0xf bank_mask:0xf
    v_add_f32_dpp v18, v18, v18 quad_perm:[1,0,3,2] row_mask:0xf bank_mask:0xf
    v_add_f32_dpp v19, v19, v19 quad_perm:[1,0,3,2] row_mask:0xf bank_mask:0xf
    v_add_f32_dpp v20, v20, v20 quad_perm:[1,0,3,2] row_mask:0xf bank_mask:0xf
    v_add_f32_dpp v21, v21, v21 quad_perm:[1,0,3,2] row_mask:0xf bank_mask:0xf
    v_add_f32_dpp v22, v22, v22 quad_perm:[1,0,3,2] row_mask:0xf bank_mask:0xf
    v_add_f32_dpp v23, v23, v23 quad_perm:[1,0,3,2] row_mask:0xf bank_mask:0xf
    v_add_f32_dpp v16, v16, v16 quad_perm:[2,3,0,1] row_mask:0xf bank_mask:0xf
    v_add_f32_dpp v17, v17, v17 quad_perm:[2,3,0,1] row_mask:0xf bank_mask:0xf
    v_add_f32_dpp v18, v18, v18 quad_perm:[2,3,0,1] row_mask:0xf bank_mask:0xf
    v_add_f32_dpp v19, v19, v19 quad_perm:[2,3,0,1] row_mask:0xf bank_mask:0xf
    v_add_f32_dpp v20, v20, v20 quad_perm:[2,3,0,1] row_mask:0xf bank_mask:0xf
    v_add_f32_dpp v21, v21, v21 quad_perm:[2,3,0,1] row_mask:0xf bank_mask:0xf
    v_add_f32_dpp v22, v22, v22 quad_perm:[2,3,0,1] row_mask:0xf bank_mask:0xf
    v_add_f32_dpp v23, v23, v23 quad_perm:[2,3,0,1] row_mask:0xf bank_mask:0xf
    v_add_f32_dpp v16, v16, v16 row_half_mirror row_mask:0xf bank_mask:0xf
    v_add_f32_dpp v17, v17, v17 row_half_mirror row_mask:0xf bank_mask:0xf
    v_add_f32_dpp v18, v18, v18 row_half_mirror row_mask:0xf bank_mask:0xf
    v_add_f32_dpp v19, v19, v19 row_half_mirror row_mask:0xf bank_mask:0xf
    v_add_f32_dpp v20, v20, v20 row_half_mirror row_mask:0xf bank_mask:0xf
    v_add_f32_dpp v21, v21, v21 row_half_mirror row_mask:0xf bank_mask:0xf
    v_add_f32_dpp v22, v22, v22 row_half_mirror row_mask:0xf bank_mask:0xf
    v_add_f32_dpp v23, v23, v23 row_half_mirror row_mask:0xf bank_mask:0xf
    v_add_f32_dpp v16, v16, v16 row_mirror row_mask:0xf bank_mask:0xf
    v_add_f32_dpp v17, v17, v17 row_mirror row_mask:0xf bank_mask:0xf
    v_add_f32_dpp v18, v18, v18 row_mirror row_mask:0xf bank_mask:0xf
    v_add_f32_dpp v19, v19, v19 row_mirror row_mask:0xf bank_mask:0xf
    v_add_f32_dpp v20, v20, v20 row_mirror row_mask:0xf bank_mask:0xf
    v_add_f32_dpp v21, v21, v21 row_mirror row_mask:0xf bank_mask:0xf
    v_add_f32_dpp v22, v22, v22 row_mirror row_mask:0xf bank_mask:0xf
    v_add_f32_dpp v23, v23, v23 row_mirror row_mask:0xf bank_mask:0xf
    v_max3_f32 v27, v16, v17, v18
    v_max3_f32 v27, v27, v19, v20
    v_max3_f32 v27, v27, v21, v22
    v_max3_f32 v24, v27, v23, v24
    v_mul_f32 v28, s28, v24
    v_sub_f32 v27, v25, v28
    v_exp_f32 v27, v27
    v_mov_b32 v25, v28
    v_fma_f32 v16, v16, s28, -v28
    v_fma_f32 v17, v17, s28, -v28
    v_fma_f32 v18, v18, s28, -v28
    v_fma_f32 v19, v19, s28, -v28
    v_fma_f32 v20, v20, s28, -v28
    v_fma_f32 v21, v21, s28, -v28
    v_fma_f32 v22, v22, s28, -v28
    v_fma_f32 v23, v23, s28, -v28
    v_exp_f32 v16, v16
    v_exp_f32 v17, v17
    v_exp_f32 v18, v18
    v_exp_f32 v19, v19
    v_exp_f32 v20, v20
    v_exp_f32 v21, v21
    v_exp_f32 v22, v22
    v_exp_f32 v23, v23
    v_mul_f32 v26, v26, v27
    v_mul_f32 v8, v8, v27
    v_mul_f32 v9, v9, v27
    v_mul_f32 v10, v10, v27
    v_mul_f32 v11, v11, v27
    v_mul_f32 v12, v12, v27
    v_mul_f32 v13, v13, v27
    v_mul_f32 v14, v14, v27
    v_mul_f32 v15, v15, v27
    v_add_f32 v26, v26, v16
    v_add_f32 v26, v26, v17
    v_add_f32 v26, v26, v18
    v_add_f32 v26, v26, v19
    v_add_f32 v26, v26, v20
    v_add_f32 v26, v26, v21
    v_add_f32 v26, v26, v22
    v_add_f32 v26, v26, v23
    s_waitcnt vmcnt(40)
    v_lshlrev_b32 v28, 16, v160
    v_and_b32 v29, s29, v160
    v_lshlrev_b32 v30, 16, v161
    v_and_b32 v31, s29, v161
    v_fmac_f32 v8, v16, v28
    v_fmac_f32 v9, v16, v29
    v_fmac_f32 v10, v16, v30
    v_fmac_f32 v11, v16, v31
    v_lshlrev_b32 v28, 16, v162
    v_and_b32 v29, s29, v162
    v_lshlrev_b32 v30, 16, v163
    v_and_b32 v31, s29, v163
    v_fmac_f32 v12, v16, v28
    v_fmac_f32 v13, v16, v29
    v_fmac_f32 v14, v16, v30
    v_fmac_f32 v15, v16, v31
    v_lshlrev_b32 v28, 16, v164
    v_and_b32 v29, s29, v164
    v_lshlrev_b32 v30, 16, v165
    v_and_b32 v31, s29, v165
    v_fmac_f32 v8, v17, v28
    v_fmac_f32 v9, v17, v29
    v_fmac_f32 v10, v17, v30
    v_fmac_f32 v11, v17, v31
    v_lshlrev_b32 v28, 16, v166
    v_and_b32 v29, s29, v166
    v_lshlrev_b32 v30, 16, v167
    v_and_b32 v31, s29, v167
    v_fmac_f32 v12, v17, v28
    v_fmac_f32 v13, v17, v29
    v_fmac_f32 v14, v17, v30
    v_fmac_f32 v15, v17, v31
    v_lshlrev_b32 v28, 16, v168
    v_and_b32 v29, s29, v168
    v_lshlrev_b32 v30, 16, v169
    v_and_b32 v31, s29, v169
    v_fmac_f32 v8, v18, v28
    v_fmac_f32 v9, v18, v29
    v_fmac_f32 v10, v18, v30
    v_fmac_f32 v11, v18, v31
    v_lshlrev_b32 v28, 16, v170
    v_and_b32 v29, s29, v170
    v_lshlrev_b32 v30, 16, v171
    v_and_b32 v31, s29, v171
    v_fmac_f32 v12, v18, v28
    v_fmac_f32 v13, v18, v29
    v_fmac_f32 v14, v18, v30
    v_fmac_f32 v15, v18, v31
    v_lshlrev_b32 v28, 16, v172
    v_and_b32 v29, s29, v172
    v_lshlrev_b32 v30, 16, v173
    v_and_b32 v31, s29, v173
    v_fmac_f32 v8, v19, v28
    v_fmac_f32 v9, v19, v29
    v_fmac_f32 v10, v19, v30
    v_fmac_f32 v11, v19, v31
    v_lshlrev_b32 v28, 16, v174
    v_and_b32 v29, s29, v174
    v_lshlrev_b32 v30, 16, v175
    v_and_b32 v31, s29, v175
    v_fmac_f32 v12, v19, v28
    v_fmac_f32 v13, v19, v29
    v_fmac_f32 v14, v19, v30
    v_fmac_f32 v15, v19, v31
    v_lshlrev_b32 v28, 16, v176
    v_and_b32 v29, s29, v176
    v_lshlrev_b32 v30, 16, v177
    v_and_b32 v31, s29, v177
    v_fmac_f32 v8, v20, v28
    v_fmac_f32 v9, v20, v29
    v_fmac_f32 v10, v20, v30
    v_fmac_f32 v11, v20, v31
    v_lshlrev_b32 v28, 16, v178
    v_and_b32 v29, s29, v178
    v_lshlrev_b32 v30, 16, v179
    v_and_b32 v31, s29, v179
    v_fmac_f32 v12, v20, v28
    v_fmac_f32 v13, v20, v29
    v_fmac_f32 v14, v20, v30
    v_fmac_f32 v15, v20, v31
    v_lshlrev_b32 v28, 16, v180
    v_and_b32 v29, s29, v180
    v_lshlrev_b32 v30, 16, v181
    v_and_b32 v31, s29, v181
    v_fmac_f32 v8, v21, v28
    v_fmac_f32 v9, v21, v29
    v_fmac_f32 v10, v21, v30
    v_fmac_f32 v11, v21, v31
    v_lshlrev_b32 v28, 16, v182
    v_and_b32 v29, s29, v182
    v_lshlrev_b32 v30, 16, v183
    v_and_b32 v31, s29, v183
    v_fmac_f32 v12, v21, v28
    v_fmac_f32 v13, v21, v29
    v_fmac_f32 v14, v21, v30
    v_fmac_f32 v15, v21, v31
    v_lshlrev_b32 v28, 16, v184
    v_and_b32 v29, s29, v184
    v_lshlrev_b32 v30, 16, v185
    v_and_b32 v31, s29, v185
    v_fmac_f32 v8, v22, v28
    v_fmac_f32 v9, v22, v29
    v_fmac_f32 v10, v22, v30
    v_fmac_f32 v11, v22, v31
    v_lshlrev_b32 v28, 16, v186
    v_and_b32 v29, s29, v186
    v_lshlrev_b32 v30, 16, v187
    v_and_b32 v31, s29, v187
    v_fmac_f32 v12, v22, v28
    v_fmac_f32 v13, v22, v29
    v_fmac_f32 v14, v22, v30
    v_fmac_f32 v15, v22, v31
    v_lshlrev_b32 v28, 16, v188
    v_and_b32 v29, s29, v188
    v_lshlrev_b32 v30, 16, v189
    v_and_b32 v31, s29, v189
    v_fmac_f32 v8, v23, v28
    v_fmac_f32 v9, v23, v29
    v_fmac_f32 v10, v23, v30
    v_fmac_f32 v11, v23, v31
    v_lshlrev_b32 v28, 16, v190
    v_and_b32 v29, s29, v190
    v_lshlrev_b32 v30, 16, v191
    v_and_b32 v31, s29, v191
    v_fmac_f32 v12, v23, v28
    v_fmac_f32 v13, v23, v29
    v_fmac_f32 v14, v23, v30
    v_fmac_f32 v15, v23, v31
    global_load_dwordx4 v[160:163], v3, s[22:23] offset:-4096 nt
    global_load_dwordx4 v[164:167], v3, s[22:23] offset:-3072 nt
    global_load_dwordx4 v[168:171], v3, s[22:23] offset:-2048 nt
    global_load_dwordx4 v[172:175], v3, s[22:23] offset:-1024 nt
    global_load_dwordx4 v[176:179], v3, s[22:23] offset:0 nt
    global_load_dwordx4 v[180:183], v3, s[22:23] offset:1024 nt
    global_load_dwordx4 v[184:187], v3, s[22:23] offset:2048 nt
    global_load_dwordx4 v[188:191], v3, s[22:23] offset:3072 nt
    s_add_u32 s22, s22, 65536
    s_addc_u32 s23, s23, 0
    s_cmp_eq_u32 s41, 0
    s_cbranch_scc1 L_noduty3
    s_waitcnt vmcnt(32)
    v_mov_b32 v40, 0
    v_mov_b32 v41, 0
    v_mov_b32 v42, 0
    v_mov_b32 v43, 0
    v_mov_b32 v44, 0
    v_mov_b32 v45, 0
    v_mov_b32 v46, 0
    v_mov_b32 v47, 0
    v_mov_b32 v48, 0
    v_mov_b32 v49, 0
    v_mov_b32 v50, 0
    v_mov_b32 v51, 0
    v_mov_b32 v52, 0
    v_mov_b32 v53, 0
    v_mov_b32 v54, 0
    v_mov_b32 v55, 0
    v_mov_b32 v56, 0
    v_mov_b32 v57, 0
    v_mov_b32 v58, 0
    v_mov_b32 v59, 0
    v_mov_b32 v60, 0
    v_mov_b32 v61, 0
    v_mov_b32 v62, 0
    v_mov_b32 v63, 0
    v_mov_b32 v240, 0
    v_mov_b32 v241, 0
    v_mov_b32 v242, 0
    v_mov_b32 v243, 0
    v_mov_b32 v244, 0
    v_mov_b32 v245, 0
    v_mov_b32 v246, 0
    v_mov_b32 v247, 0
    v_lshlrev_b32 v248, 16, v192
    v_and_b32 v249, s29, v192
    v_lshlrev_b32 v250, 16, v193
    v_and_b32 v251, s29, v193
    v_lshlrev_b32 v252, 16, v194
    v_and_b32 v253, s29, v194
    v_lshlrev_b32 v254, 16, v195
    v_and_b32 v255, s29, v195
    v_fmac_f32 v40, v32, v248
    v_fmac_f32 v41, v32, v249
    v_fmac_f32 v42, v32, v250
    v_fmac_f32 v43, v32, v251
    v_fmac_f32 v44, v32, v252
    v_fmac_f32 v45, v32, v253
    v_fmac_f32 v46, v32, v254
    v_fmac_f32 v47, v32, v255
    v_fmac_f32 v48, v36, v248
    v_fmac_f32 v49, v36, v249
    v_fmac_f32 v50, v36, v250
    v_fmac_f32 v51, v36, v251
    v_fmac_f32 v52, v36, v252
    v_fmac_f32 v53, v36, v253
    v_fmac_f32 v54, v36, v254
    v_fmac_f32 v55, v36, v255
    v_lshlrev_b32 v248, 16, v208
    v_and_b32 v249, s29, v208
    v_lshlrev_b32 v250, 16, v209
    v_and_b32 v251, s29, v209
    v_lshlrev_b32 v252, 16, v210
    v_and_b32 v253, s29, v210
    v_lshlrev_b32 v254, 16, v211
    v_and_b32 v255, s29, v211
    v_fmac_f32 v56, v32, v248
    v_fmac_f32 v57, v32, v249
    v_fmac_f32 v58, v32, v250
    v_fmac_f32 v59, v32, v251
    v_fmac_f32 v60, v32, v252
    v_fmac_f32 v61, v32, v253
    v_fmac_f32 v62, v32, v254
    v_fmac_f32 v63, v32, v255
    v_fmac_f32 v240, v36, v248
    v_fmac_f32 v241, v36, v249
    v_fmac_f32 v242, v36, v250
    v_fmac_f32 v243, v36, v251
    v_fmac_f32 v244, v36, v252
    v_fmac_f32 v245, v36, v253
    v_fmac_f32 v246, v36, v254
    v_fmac_f32 v247, v36, v255
    v_lshlrev_b32 v248, 16, v196
    v_and_b32 v249, s29, v196
    v_lshlrev_b32 v250, 16, v197
    v_and_b32 v251, s29, v197
    v_lshlrev_b32 v252, 16, v198
    v_and_b32 v253, s29, v198
    v_lshlrev_b32 v254, 16, v199
    v_and_b32 v255, s29, v199
    v_fmac_f32 v40, v33, v248
    v_fmac_f32 v41, v33, v249
    v_fmac_f32 v42, v33, v250
    v_fmac_f32 v43, v33, v251
    v_fmac_f32 v44, v33, v252
    v_fmac_f32 v45, v33, v253
    v_fmac_f32 v46, v33, v254
    v_fmac_f32 v47, v33, v255
    v_fmac_f32 v48, v37, v248
    v_fmac_f32 v49, v37, v249
    v_fmac_f32 v50, v37, v250
    v_fmac_f32 v51, v37, v251
    v_fmac_f32 v52, v37, v252
    v_fmac_f32 v53, v37, v253
    v_fmac_f32 v54, v37, v254
    v_fmac_f32 v55, v37, v255
    v_lshlrev_b32 v248, 16, v212
    v_and_b32 v249, s29, v212
    v_lshlrev_b32 v250, 16, v213
    v_and_b32 v251, s29, v213
    v_lshlrev_b32 v252, 16, v214
    v_and_b32 v253, s29, v214
    v_lshlrev_b32 v254, 16, v215
    v_and_b32 v255, s29, v215
    v_fmac_f32 v56, v33, v248
    v_fmac_f32 v57, v33, v249
    v_fmac_f32 v58, v33, v250
    v_fmac_f32 v59, v33, v251
    v_fmac_f32 v60, v33, v252
    v_fmac_f32 v61, v33, v253
    v_fmac_f32 v62, v33, v254
    v_fmac_f32 v63, v33, v255
    v_fmac_f32 v240, v37, v248
    v_fmac_f32 v241, v37, v249
    v_fmac_f32 v242, v37, v250
    v_fmac_f32 v243, v37, v251
    v_fmac_f32 v244, v37, v252
    v_fmac_f32 v245, v37, v253
    v_fmac_f32 v246, v37, v254
    v_fmac_f32 v247, v37, v255
    v_lshlrev_b32 v248, 16, v200
    v_and_b32 v249, s29, v200
    v_lshlrev_b32 v250, 16, v201
    v_and_b32 v251, s29, v201
    v_lshlrev_b32 v252, 16, v202
    v_and_b32 v253, s29, v202
    v_lshlrev_b32 v254, 16, v203
    v_and_b32 v255, s29, v203
    v_fmac_f32 v40, v34, v248
    v_fmac_f32 v41, v34, v249
    v_fmac_f32 v42, v34, v250
    v_fmac_f32 v43, v34, v251
    v_fmac_f32 v44, v34, v252
    v_fmac_f32 v45, v34, v253
    v_fmac_f32 v46, v34, v254
    v_fmac_f32 v47, v34, v255
    v_fmac_f32 v48, v38, v248
    v_fmac_f32 v49, v38, v249
    v_fmac_f32 v50, v38, v250
    v_fmac_f32 v51, v38, v251
    v_fmac_f32 v52, v38, v252
    v_fmac_f32 v53, v38, v253
    v_fmac_f32 v54, v38, v254
    v_fmac_f32 v55, v38, v255
    v_lshlrev_b32 v248, 16, v216
    v_and_b32 v249, s29, v216
    v_lshlrev_b32 v250, 16, v217
    v_and_b32 v251, s29, v217
    v_lshlrev_b32 v252, 16, v218
    v_and_b32 v253, s29, v218
    v_lshlrev_b32 v254, 16, v219
    v_and_b32 v255, s29, v219
    v_fmac_f32 v56, v34, v248
    v_fmac_f32 v57, v34, v249
    v_fmac_f32 v58, v34, v250
    v_fmac_f32 v59, v34, v251
    v_fmac_f32 v60, v34, v252
    v_fmac_f32 v61, v34, v253
    v_fmac_f32 v62, v34, v254
    v_fmac_f32 v63, v34, v255
    v_fmac_f32 v240, v38, v248
    v_fmac_f32 v241, v38, v249
    v_fmac_f32 v242, v38, v250
    v_fmac_f32 v243, v38, v251
    v_fmac_f32 v244, v38, v252
    v_fmac_f32 v245, v38, v253
    v_fmac_f32 v246, v38, v254
    v_fmac_f32 v247, v38, v255
    v_lshlrev_b32 v248, 16, v204
    v_and_b32 v249, s29, v204
    v_lshlrev_b32 v250, 16, v205
    v_and_b32 v251, s29, v205
    v_lshlrev_b32 v252, 16, v206
    v_and_b32 v253, s29, v206
    v_lshlrev_b32 v254, 16, v207
    v_and_b32 v255, s29, v207
    v_fmac_f32 v40, v35, v248
    v_fmac_f32 v41, v35, v249
    v_fmac_f32 v42, v35, v250
    v_fmac_f32 v43, v35, v251
    v_fmac_f32 v44, v35, v252
    v_fmac_f32 v45, v35, v253
    v_fmac_f32 v46, v35, v254
    v_fmac_f32 v47, v35, v255
    v_fmac_f32 v48, v39, v248
    v_fmac_f32 v49, v39, v249
    v_fmac_f32 v50, v39, v250
    v_fmac_f32 v51, v39, v251
    v_fmac_f32 v52, v39, v252
    v_fmac_f32 v53, v39, v253
    v_fmac_f32 v54, v39, v254
    v_fmac_f32 v55, v39, v255
    v_lshlrev_b32 v248, 16, v220
    v_and_b32 v249, s29, v220
    v_lshlrev_b32 v250, 16, v221
    v_and_b32 v251, s29, v221
    v_lshlrev_b32 v252, 16, v222
    v_and_b32 v253, s29, v222
    v_lshlrev_b32 v254, 16, v223
    v_and_b32 v255, s29, v223
    v_fmac_f32 v56, v35, v248
    v_fmac_f32 v57, v35, v249
    v_fmac_f32 v58, v35, v250
    v_fmac_f32 v59, v35, v251
    v_fmac_f32 v60, v35, v252
    v_fmac_f32 v61, v35, v253
    v_fmac_f32 v62, v35, v254
    v_fmac_f32 v63, v35, v255
    v_fmac_f32 v240, v39, v248
    v_fmac_f32 v241, v39, v249
    v_fmac_f32 v242, v39, v250
    v_fmac_f32 v243, v39, v251
    v_fmac_f32 v244, v39, v252
    v_fmac_f32 v245, v39, v253
    v_fmac_f32 v246, v39, v254
    v_fmac_f32 v247, v39, v255
    s_nop 1
    v_add_f32_dpp v40, v40, v40 row_ror:4 row_mask:0xf bank_mask:0xf
    v_add_f32_dpp v41, v41, v41 row_ror:4 row_mask:0xf bank_mask:0xf
    v_add_f32_dpp v42, v42, v42 row_ror:4 row_mask:0xf bank_mask:0xf
    v_add_f32_dpp v43, v43, v43 row_ror:4 row_mask:0xf bank_mask:0xf
    v_add_f32_dpp v44, v44, v44 row_ror:4 row_mask:0xf bank_mask:0xf
    v_add_f32_dpp v45, v45, v45 row_ror:4 row_mask:0xf bank_mask:0xf
    v_add_f32_dpp v46, v46, v46 row_ror:4 row_mask:0xf bank_mask:0xf
    v_add_f32_dpp v47, v47, v47 row_ror:4 row_mask:0xf bank_mask:0xf
    v_add_f32_dpp v48, v48, v48 row_ror:4 row_mask:0xf bank_mask:0xf
    v_add_f32_dpp v49, v49, v49 row_ror:4 row_mask:0xf bank_mask:0xf
    v_add_f32_dpp v50, v50, v50 row_ror:4 row_mask:0xf bank_mask:0xf
    v_add_f32_dpp v51, v51, v51 row_ror:4 row_mask:0xf bank_mask:0xf
    v_add_f32_dpp v52, v52, v52 row_ror:4 row_mask:0xf bank_mask:0xf
    v_add_f32_dpp v53, v53, v53 row_ror:4 row_mask:0xf bank_mask:0xf
    v_add_f32_dpp v54, v54, v54 row_ror:4 row_mask:0xf bank_mask:0xf
    v_add_f32_dpp v55, v55, v55 row_ror:4 row_mask:0xf bank_mask:0xf
    v_add_f32_dpp v56, v56, v56 row_ror:4 row_mask:0xf bank_mask:0xf
    v_add_f32_dpp v57, v57, v57 row_ror:4 row_mask:0xf bank_mask:0xf
    v_add_f32_dpp v58, v58, v58 row_ror:4 row_mask:0xf bank_mask:0xf
    v_add_f32_dpp v59, v59, v59 row_ror:4 row_mask:0xf bank_mask:0xf
    v_add_f32_dpp v60, v60, v60 row_ror:4 row_mask:0xf bank_mask:0xf
    v_add_f32_dpp v61, v61, v61 row_ror:4 row_mask:0xf bank_mask:0xf
    v_add_f32_dpp v62, v62, v62 row_ror:4 row_mask:0xf bank_mask:0xf
    v_add_f32_dpp v63, v63, v63 row_ror:4 row_mask:0xf bank_mask:0xf
    v_add_f32_dpp v240, v240, v240 row_ror:4 row_mask:0xf bank_mask:0xf
    v_add_f32_dpp v241, v241, v241 row_ror:4 row_mask:0xf bank_mask:0xf
    v_add_f32_dpp v242, v242, v242 row_ror:4 row_mask:0xf bank_mask:0xf
    v_add_f32_dpp v243, v243, v243 row_ror:4 row_mask:0xf bank_mask:0xf
    v_add_f32_dpp v244, v244, v244 row_ror:4 row_mask:0xf bank_mask:0xf
    v_add_f32_dpp v245, v245, v245 row_ror:4 row_mask:0xf bank_mask:0xf
    v_add_f32_dpp v246, v246, v246 row_ror:4 row_mask:0xf bank_mask:0xf
    v_add_f32_dpp v247, v247, v247 row_ror:4 row_mask:0xf bank_mask:0xf
    v_add_f32_dpp v40, v40, v40 row_ror:8 row_mask:0xf bank_mask:0xf
    v_add_f32_dpp v41, v41, v41 row_ror:8 row_mask:0xf bank_mask:0xf
    v_add_f32_dpp v42, v42, v42 row_ror:8 row_mask:0xf bank_mask:0xf
    v_add_f32_dpp v43, v43, v43 row_ror:8 row_mask:0xf bank_mask:0xf
    v_add_f32_dpp v44, v44, v44 row_ror:8 row_mask:0xf bank_mask:0xf
    v_add_f32_dpp v45, v45, v45 row_ror:8 row_mask:0xf bank_mask:0xf
    v_add_f32_dpp v46, v46, v46 row_ror:8 row_mask:0xf bank_mask:0xf
    v_add_f32_dpp v47, v47, v47 row_ror:8 row_mask:0xf bank_mask:0xf
    v_add_f32_dpp v48, v48, v48 row_ror:8 row_mask:0xf bank_mask:0xf
    v_add_f32_dpp v49, v49, v49 row_ror:8 row_mask:0xf bank_mask:0xf
    v_add_f32_dpp v50, v50, v50 row_ror:8 row_mask:0xf bank_mask:0xf
    v_add_f32_dpp v51, v51, v51 row_ror:8 row_mask:0xf bank_mask:0xf
    v_add_f32_dpp v52, v52, v52 row_ror:8 row_mask:0xf bank_mask:0xf
    v_add_f32_dpp v53, v53, v53 row_ror:8 row_mask:0xf bank_mask:0xf
    v_add_f32_dpp v54, v54, v54 row_ror:8 row_mask:0xf bank_mask:0xf
    v_add_f32_dpp v55, v55, v55 row_ror:8 row_mask:0xf bank_mask:0xf
    v_add_f32_dpp v56, v56, v56 row_ror:8 row_mask:0xf bank_mask:0xf
    v_add_f32_dpp v57, v57, v57 row_ror:8 row_mask:0xf bank_mask:0xf
    v_add_f32_dpp v58, v58, v58 row_ror:8 row_mask:0xf bank_mask:0xf
    v_add_f32_dpp v59, v59, v59 row_ror:8 row_mask:0xf bank_mask:0xf
    v_add_f32_dpp v60, v60, v60 row_ror:8 row_mask:0xf bank_mask:0xf
    v_add_f32_dpp v61, v61, v61 row_ror:8 row_mask:0xf bank_mask:0xf
    v_add_f32_dpp v62, v62, v62 row_ror:8 row_mask:0xf bank_mask:0xf
    v_add_f32_dpp v63, v63, v63 row_ror:8 row_mask:0xf bank_mask:0xf
    v_add_f32_dpp v240, v240, v240 row_ror:8 row_mask:0xf bank_mask:0xf
    v_add_f32_dpp v241, v241, v241 row_ror:8 row_mask:0xf bank_mask:0xf
    v_add_f32_dpp v242, v242, v242 row_ror:8 row_mask:0xf bank_mask:0xf
    v_add_f32_dpp v243, v243, v243 row_ror:8 row_mask:0xf bank_mask:0xf
    v_add_f32_dpp v244, v244, v244 row_ror:8 row_mask:0xf bank_mask:0xf
    v_add_f32_dpp v245, v245, v245 row_ror:8 row_mask:0xf bank_mask:0xf
    v_add_f32_dpp v246, v246, v246 row_ror:8 row_mask:0xf bank_mask:0xf
    v_add_f32_dpp v247, v247, v247 row_ror:8 row_mask:0xf bank_mask:0xf
    v_lshrrev_b32 v32, 4, v1
    s_lshl_b32 s36, s19, 2
    v_add_u32 v32, s36, v32
    v_lshlrev_b32 v32, 9, v32
    v_and_b32 v33, 3, v1
    v_lshl_add_u32 v32, v33, 5, v32
    ds_write_b128 v32, v[40:43] offset:37120
    ds_write_b128 v32, v[44:47] offset:37136
    ds_write_b128 v32, v[48:51] offset:37248
    ds_write_b128 v32, v[52:55] offset:37264
    ds_write_b128 v32, v[56:59] offset:37376
    ds_write_b128 v32, v[60:63] offset:37392
    ds_write_b128 v32, v[240:243] offset:37504
    ds_write_b128 v32, v[244:247] offset:37520
    s_waitcnt lgkmcnt(0)
    s_barrier
    s_cmp_lg_u32 s19, 0
    s_cbranch_scc1 L_ffn_skip
    v_lshlrev_b32 v32, 2, v1
    ds_read_b32 v192, v32 offset:37120
    ds_read_b32 v208, v32 offset:37376
    ds_read_b32 v193, v32 offset:37632
    ds_read_b32 v209, v32 offset:37888
    ds_read_b32 v194, v32 offset:38144
    ds_read_b32 v210, v32 offset:38400
    ds_read_b32 v195, v32 offset:38656
    ds_read_b32 v211, v32 offset:38912
    ds_read_b32 v196, v32 offset:39168
    ds_read_b32 v212, v32 offset:39424
    ds_read_b32 v197, v32 offset:39680
    ds_read_b32 v213, v32 offset:39936
    ds_read_b32 v198, v32 offset:40192
    ds_read_b32 v214, v32 offset:40448
    ds_read_b32 v199, v32 offset:40704
    ds_read_b32 v215, v32 offset:40960
    ds_read_b32 v200, v32 offset:41216
    ds_read_b32 v216, v32 offset:41472
    ds_read_b32 v201, v32 offset:41728
    ds_read_b32 v217, v32 offset:41984
    ds_read_b32 v202, v32 offset:42240
    ds_read_b32 v218, v32 offset:42496
    ds_read_b32 v203, v32 offset:42752
    ds_read_b32 v219, v32 offset:43008
    ds_read_b32 v204, v32 offset:43264
    ds_read_b32 v220, v32 offset:43520
    ds_read_b32 v205, v32 offset:43776
    ds_read_b32 v221, v32 offset:44032
    ds_read_b32 v206, v32 offset:44288
    ds_read_b32 v222, v32 offset:44544
    ds_read_b32 v207, v32 offset:44800
    ds_read_b32 v223, v32 offset:45056
    s_waitcnt lgkmcnt(0)
    v_add_f32 v56, v192, v193
    v_add_f32 v57, v208, v209
    v_add_f32 v56, v56, v194
    v_add_f32 v57, v57, v210
    v_add_f32 v56, v56, v195
    v_add_f32 v57, v57, v211
    v_add_f32 v56, v56, v196
    v_add_f32 v57, v57, v212
    v_add_f32 v56, v56, v197
    v_add_f32 v57, v57, v213
    v_add_f32 v56, v56, v198
    v_add_f32 v57, v57, v214
    v_add_f32 v56, v56, v199
    v_add_f32 v57, v57, v215
    v_add_f32 v56, v56, v200
    v_add_f32 v57, v57, v216
    v_add_f32 v56, v56, v201
    v_add_f32 v57, v57, v217
    v_add_f32 v56, v56, v202
    v_add_f32 v57, v57, v218
    v_add_f32 v56, v56, v203
    v_add_f32 v57, v57, v219
    v_add_f32 v56, v56, v204
    v_add_f32 v57, v57, v220
    v_add_f32 v56, v56, v205
    v_add_f32 v57, v57, v221
    v_add_f32 v56, v56, v206
    v_add_f32 v57, v57, v222
    v_add_f32 v56, v56, v207
    v_add_f32 v57, v57, v223
    ds_read_b32 v192, v32 offset:45312
    ds_read_b32 v208, v32 offset:45568
    ds_read_b32 v193, v32 offset:45824
    ds_read_b32 v209, v32 offset:46080
    ds_read_b32 v194, v32 offset:46336
    ds_read_b32 v210, v32 offset:46592
    ds_read_b32 v195, v32 offset:46848
    ds_read_b32 v211, v32 offset:47104
    ds_read_b32 v196, v32 offset:47360
    ds_read_b32 v212, v32 offset:47616
    ds_read_b32 v197, v32 offset:47872
    ds_read_b32 v213, v32 offset:48128
    ds_read_b32 v198, v32 offset:48384
    ds_read_b32 v214, v32 offset:48640
    ds_read_b32 v199, v32 offset:48896
    ds_read_b32 v215, v32 offset:49152
    ds_read_b32 v200, v32 offset:49408
    ds_read_b32 v216, v32 offset:49664
    ds_read_b32 v201, v32 offset:49920
    ds_read_b32 v217, v32 offset:50176
    ds_read_b32 v202, v32 offset:50432
    ds_read_b32 v218, v32 offset:50688
    ds_read_b32 v203, v32 offset:50944
    ds_read_b32 v219, v32 offset:51200
    ds_read_b32 v204, v32 offset:51456
    ds_read_b32 v220, v32 offset:51712
    ds_read_b32 v205, v32 offset:51968
    ds_read_b32 v221, v32 offset:52224
    ds_read_b32 v206, v32 offset:52480
    ds_read_b32 v222, v32 offset:52736
    ds_read_b32 v207, v32 offset:52992
    ds_read_b32 v223, v32 offset:53248
    s_waitcnt lgkmcnt(0)
    v_add_f32 v56, v56, v192
    v_add_f32 v57, v57, v208
    v_add_f32 v56, v56, v193
    v_add_f32 v57, v57, v209
    v_add_f32 v56, v56, v194
    v_add_f32 v57, v57, v210
    v_add_f32 v56, v56, v195
    v_add_f32 v57, v57, v211
    v_add_f32 v56, v56, v196
    v_add_f32 v57, v57, v212
    v_add_f32 v56, v56, v197
    v_add_f32 v57, v57, v213
    v_add_f32 v56, v56, v198
    v_add_f32 v57, v57, v214
    v_add_f32 v56, v56, v199
    v_add_f32 v57, v57, v215
    v_add_f32 v56, v56, v200
    v_add_f32 v57, v57, v216
    v_add_f32 v56, v56, v201
    v_add_f32 v57, v57, v217
    v_add_f32 v56, v56, v202
    v_add_f32 v57, v57, v218
    v_add_f32 v56, v56, v203
    v_add_f32 v57, v57, v219
    v_add_f32 v56, v56, v204
    v_add_f32 v57, v57, v220
    v_add_f32 v56, v56, v205
    v_add_f32 v57, v57, v221
    v_add_f32 v56, v56, v206
    v_add_f32 v57, v57, v222
    v_add_f32 v56, v56, v207
    v_add_f32 v57, v57, v223
    v_cvt_pk_bf16_f32 v56, v56, v56
    v_and_b32 v56, 0xffff0000, v56
    v_cvt_pk_bf16_f32 v57, v57, v57
    v_and_b32 v57, 0xffff0000, v57
    v_mul_f32 v58, v56, v56
    v_mul_f32 v58, 0x3d372713, v58
    v_add_f32 v58, 1.0, v58
    v_mul_f32 v58, v58, v56
    v_mul_f32 v58, 0xc0135761, v58
    v_exp_f32 v58, v58
    s_nop 0
    v_add_f32 v58, 1.0, v58
    v_rcp_f32 v58, v58
    s_nop 0
    v_mul_f32 v58, v58, v56
    v_cvt_pk_bf16_f32 v58, v58, v58
    v_and_b32 v58, 0xffff0000, v58
    v_mul_f32 v58, v58, v57
    v_cvt_pk_bf16_f32 v58, v58, v58
    v_and_b32 v58, 0xffff0000, v58
    ds_write_b32 v32, v58 offset:53504
    s_waitcnt lgkmcnt(0)
L_ffn_skip:
    s_barrier
    s_lshl_b32 s36, s19, 4
    v_mov_b32 v63, s36
    ds_read_b128 v[32:35], v63 offset:53504
    ds_read_b128 v[36:39], v63 offset:53632
    v_mov_b32 v40, 0
    v_mov_b32 v41, 0
    v_mov_b32 v42, 0
    v_mov_b32 v43, 0
    v_mov_b32 v44, 0
    v_mov_b32 v45, 0
    v_mov_b32 v46, 0
    v_mov_b32 v47, 0
    v_mov_b32 v48, 0
    v_mov_b32 v49, 0
    v_mov_b32 v50, 0
    v_mov_b32 v51, 0
    v_mov_b32 v52, 0
    v_mov_b32 v53, 0
    v_mov_b32 v54, 0
    v_mov_b32 v55, 0
    s_waitcnt lgkmcnt(0)
    v_lshlrev_b32 v248, 16, v224
    v_and_b32 v249, s29, v224
    v_lshlrev_b32 v250, 16, v225
    v_and_b32 v251, s29, v225
    v_lshlrev_b32 v252, 16, v226
    v_and_b32 v253, s29, v226
    v_lshlrev_b32 v254, 16, v227
    v_and_b32 v255, s29, v227
    v_fmac_f32 v40, v32, v248
    v_fmac_f32 v41, v32, v249
    v_fmac_f32 v42, v32, v250
    v_fmac_f32 v43, v32, v251
    v_fmac_f32 v44, v32, v252
    v_fmac_f32 v45, v32, v253
    v_fmac_f32 v46, v32, v254
    v_fmac_f32 v47, v32, v255
    v_fmac_f32 v48, v36, v248
    v_fmac_f32 v49, v36, v249
    v_fmac_f32 v50, v36, v250
    v_fmac_f32 v51, v36, v251
    v_fmac_f32 v52, v36, v252
    v_fmac_f32 v53, v36, v253
    v_fmac_f32 v54, v36, v254
    v_fmac_f32 v55, v36, v255
    v_lshlrev_b32 v248, 16, v228
    v_and_b32 v249, s29, v228
    v_lshlrev_b32 v250, 16, v229
    v_and_b32 v251, s29, v229
    v_lshlrev_b32 v252, 16, v230
    v_and_b32 v253, s29, v230
    v_lshlrev_b32 v254, 16, v231
    v_and_b32 v255, s29, v231
    v_fmac_f32 v40, v33, v248
    v_fmac_f32 v41, v33, v249
    v_fmac_f32 v42, v33, v250
    v_fmac_f32 v43, v33, v251
    v_fmac_f32 v44, v33, v252
    v_fmac_f32 v45, v33, v253
    v_fmac_f32 v46, v33, v254
    v_fmac_f32 v47, v33, v255
    v_fmac_f32 v48, v37, v248
    v_fmac_f32 v49, v37, v249
    v_fmac_f32 v50, v37, v250
    v_fmac_f32 v51, v37, v251
    v_fmac_f32 v52, v37, v252
    v_fmac_f32 v53, v37, v253
    v_fmac_f32 v54, v37, v254
    v_fmac_f32 v55, v37, v255
    v_lshlrev_b32 v248, 16, v232
    v_and_b32 v249, s29, v232
    v_lshlrev_b32 v250, 16, v233
    v_and_b32 v251, s29, v233
    v_lshlrev_b32 v252, 16, v234
    v_and_b32 v253, s29, v234
    v_lshlrev_b32 v254, 16, v235
    v_and_b32 v255, s29, v235
    v_fmac_f32 v40, v34, v248
    v_fmac_f32 v41, v34, v249
    v_fmac_f32 v42, v34, v250
    v_fmac_f32 v43, v34, v251
    v_fmac_f32 v44, v34, v252
    v_fmac_f32 v45, v34, v253
    v_fmac_f32 v46, v34, v254
    v_fmac_f32 v47, v34, v255
    v_fmac_f32 v48, v38, v248
    v_fmac_f32 v49, v38, v249
    v_fmac_f32 v50, v38, v250
    v_fmac_f32 v51, v38, v251
    v_fmac_f32 v52, v38, v252
    v_fmac_f32 v53, v38, v253
    v_fmac_f32 v54, v38, v254
    v_fmac_f32 v55, v38, v255
    v_lshlrev_b32 v248, 16, v236
    v_and_b32 v249, s29, v236
    v_lshlrev_b32 v250, 16, v237
    v_and_b32 v251, s29, v237
    v_lshlrev_b32 v252, 16, v238
    v_and_b32 v253, s29, v238
    v_lshlrev_b32 v254, 16, v239
    v_and_b32 v255, s29, v239
    v_fmac_f32 v40, v35, v248
    v_fmac_f32 v41, v35, v249
    v_fmac_f32 v42, v35, v250
    v_fmac_f32 v43, v35, v251
    v_fmac_f32 v44, v35, v252
    v_fmac_f32 v45, v35, v253
    v_fmac_f32 v46, v35, v254
    v_fmac_f32 v47, v35, v255
    v_fmac_f32 v48, v39, v248
    v_fmac_f32 v49, v39, v249
    v_fmac_f32 v50, v39, v250
    v_fmac_f32 v51, v39, v251
    v_fmac_f32 v52, v39, v252
    v_fmac_f32 v53, v39, v253
    v_fmac_f32 v54, v39, v254
    v_fmac_f32 v55, v39, v255
    v_lshlrev_b32 v63, 5, v1
    s_lshl_b32 s36, s19, 12
    s_add_u32 s36, s36, 53760
    v_add_u32 v63, s36, v63
    ds_write_b128 v63, v[40:43] offset:0
    ds_write_b128 v63, v[44:47] offset:16
    ds_write_b128 v63, v[48:51] offset:2048
    ds_write_b128 v63, v[52:55] offset:2064
    v_lshlrev_b32 v62, 2, v0
    v_add_u32 v61, 53760, v62
    s_lshl_b32 s36, s42, 12
    s_add_u32 s36, s36, 1048576
    s_add_u32 s44, s14, s36
    s_addc_u32 s45, s15, 0
    s_waitcnt lgkmcnt(0)
    s_barrier
    ds_read_b32 v32, v61 offset:0
    ds_read_b32 v33, v61 offset:4096
    ds_read_b32 v34, v61 offset:8192
    ds_read_b32 v35, v61 offset:12288
    ds_read_b32 v36, v61 offset:16384
    ds_read_b32 v37, v61 offset:20480
    ds_read_b32 v38, v61 offset:24576
    ds_read_b32 v39, v61 offset:28672
    ds_read_b32 v40, v61 offset:2048
    ds_read_b32 v41, v61 offset:6144
    ds_read_b32 v42, v61 offset:10240
    ds_read_b32 v43, v61 offset:14336
    ds_read_b32 v44, v61 offset:18432
    ds_read_b32 v45, v61 offset:22528
    ds_read_b32 v46, v61 offset:26624
    ds_read_b32 v47, v61 offset:30720
    global_load_dwordx4 v[192:195], v3, s[26:27] offset:-4096
    global_load_dwordx4 v[196:199], v3, s[26:27] offset:-3072
    global_load_dwordx4 v[200:203], v3, s[26:27] offset:-2048
    global_load_dwordx4 v[204:207], v3, s[26:27] offset:-1024
    global_load_dwordx4 v[208:211], v3, s[26:27] offset:0
    global_load_dwordx4 v[212:215], v3, s[26:27] offset:1024
    global_load_dwordx4 v[216:219], v3, s[26:27] offset:2048
    global_load_dwordx4 v[220:223], v3, s[26:27] offset:3072
    s_add_u32 s26, s26, 65536
    s_addc_u32 s27, s27, 0
    global_load_dwordx4 v[224:227], v3, s[26:27] offset:-4096
    global_load_dwordx4 v[228:231], v3, s[26:27] offset:-3072
    global_load_dwordx4 v[232:235], v3, s[26:27] offset:-2048
    global_load_dwordx4 v[236:239], v3, s[26:27] offset:-1024
    global_load_dwordx4 v[240:243], v3, s[26:27] offset:0
    global_load_dwordx4 v[244:247], v3, s[26:27] offset:1024
    global_load_dwordx4 v[248:251], v3, s[26:27] offset:2048
    global_load_dwordx4 v[252:255], v3, s[26:27] offset:3072
    s_waitcnt lgkmcnt(0)
    v_add_f32 v56, v32, v33
    v_add_f32 v56, v56, v34
    v_add_f32 v56, v56, v35
    v_add_f32 v56, v56, v36
    v_add_f32 v56, v56, v37
    v_add_f32 v56, v56, v38
    v_add_f32 v56, v56, v39
    v_add_f32 v57, v40, v41
    v_add_f32 v57, v57, v42
    v_add_f32 v57, v57, v43
    v_add_f32 v57, v57, v44
    v_add_f32 v57, v57, v45
    v_add_f32 v57, v57, v46
    v_add_f32 v57, v57, v47
    global_store_dword v62, v56, s[44:45]
    global_store_dword v62, v57, s[44:45] offset:2048
L_noduty3:
    s_waitcnt vmcnt(24)
    v_dot2_f32_bf16 v16, v64, v4, 0
    v_dot2_f32_bf16 v17, v68, v4, 0
    v_dot2_f32_bf16 v18, v72, v4, 0
    v_dot2_f32_bf16 v19, v76, v4, 0
    v_dot2_f32_bf16 v20, v80, v4, 0
    v_dot2_f32_bf16 v21, v84, v4, 0
    v_dot2_f32_bf16 v22, v88, v4, 0
    v_dot2_f32_bf16 v23, v92, v4, 0
    v_dot2_f32_bf16 v16, v65, v5, v16
    v_dot2_f32_bf16 v17, v69, v5, v17
    v_dot2_f32_bf16 v18, v73, v5, v18
    v_dot2_f32_bf16 v19, v77, v5, v19
    v_dot2_f32_bf16 v20, v81, v5, v20
    v_dot2_f32_bf16 v21, v85, v5, v21
    v_dot2_f32_bf16 v22, v89, v5, v22
    v_dot2_f32_bf16 v23, v93, v5, v23
    v_dot2_f32_bf16 v16, v66, v6, v16
    v_dot2_f32_bf16 v17, v70, v6, v17
    v_dot2_f32_bf16 v18, v74, v6, v18
    v_dot2_f32_bf16 v19, v78, v6, v19
    v_dot2_f32_bf16 v20, v82, v6, v20
    v_dot2_f32_bf16 v21, v86, v6, v21
    v_dot2_f32_bf16 v22, v90, v6, v22
    v_dot2_f32_bf16 v23, v94, v6, v23
    v_dot2_f32_bf16 v16, v67, v7, v16
    v_dot2_f32_bf16 v17, v71, v7, v17
    v_dot2_f32_bf16 v18, v75, v7, v18
    v_dot2_f32_bf16 v19, v79, v7, v19
    v_dot2_f32_bf16 v20, v83, v7, v20
    v_dot2_f32_bf16 v21, v87, v7, v21
    v_dot2_f32_bf16 v22, v91, v7, v22
    v_dot2_f32_bf16 v23, v95, v7, v23
    global_load_dwordx4 v[64:67], v3, s[20:21] offset:-4096 nt
    global_load_dwordx4 v[68:71], v3, s[20:21] offset:-3072 nt
    global_load_dwordx4 v[72:75], v3, s[20:21] offset:-2048 nt
    global_load_dwordx4 v[76:79], v3, s[20:21] offset:-1024 nt
    global_load_dwordx4 v[80:83], v3, s[20:21] offset:0 nt
    global_load_dwordx4 v[84:87], v3, s[20:21] offset:1024 nt
    global_load_dwordx4 v[88:91], v3, s[20:21] offset:2048 nt
    global_load_dwordx4 v[92:95], v3, s[20:21] offset:3072 nt
    s_add_u32 s20, s20, 65536
    s_addc_u32 s21, s21, 0
    v_add_f32_dpp v16, v16, v16 quad_perm:[1,0,3,2] row_mask:0xf bank_mask:0xf
    v_add_f32_dpp v17, v17, v17 quad_perm:[1,0,3,2] row_mask:0xf bank_mask:0xf
    v_add_f32_dpp v18, v18, v18 quad_perm:[1,0,3,2] row_mask:0xf bank_mask:0xf
    v_add_f32_dpp v19, v19, v19 quad_perm:[1,0,3,2] row_mask:0xf bank_mask:0xf
    v_add_f32_dpp v20, v20, v20 quad_perm:[1,0,3,2] row_mask:0xf bank_mask:0xf
    v_add_f32_dpp v21, v21, v21 quad_perm:[1,0,3,2] row_mask:0xf bank_mask:0xf
    v_add_f32_dpp v22, v22, v22 quad_perm:[1,0,3,2] row_mask:0xf bank_mask:0xf
    v_add_f32_dpp v23, v23, v23 quad_perm:[1,0,3,2] row_mask:0xf bank_mask:0xf
    v_add_f32_dpp v16, v16, v16 quad_perm:[2,3,0,1] row_mask:0xf bank_mask:0xf
    v_add_f32_dpp v17, v17, v17 quad_perm:[2,3,0,1] row_mask:0xf bank_mask:0xf
    v_add_f32_dpp v18, v18, v18 quad_perm:[2,3,0,1] row_mask:0xf bank_mask:0xf
    v_add_f32_dpp v19, v19, v19 quad_perm:[2,3,0,1] row_mask:0xf bank_mask:0xf
    v_add_f32_dpp v20, v20, v20 quad_perm:[2,3,0,1] row_mask:0xf bank_mask:0xf
    v_add_f32_dpp v21, v21, v21 quad_perm:[2,3,0,1] row_mask:0xf bank_mask:0xf
    v_add_f32_dpp v22, v22, v22 quad_perm:[2,3,0,1] row_mask:0xf bank_mask:0xf
    v_add_f32_dpp v23, v23, v23 quad_perm:[2,3,0,1] row_mask:0xf bank_mask:0xf
    v_add_f32_dpp v16, v16, v16 row_half_mirror row_mask:0xf bank_mask:0xf
    v_add_f32_dpp v17, v17, v17 row_half_mirror row_mask:0xf bank_mask:0xf
    v_add_f32_dpp v18, v18, v18 row_half_mirror row_mask:0xf bank_mask:0xf
    v_add_f32_dpp v19, v19, v19 row_half_mirror row_mask:0xf bank_mask:0xf
    v_add_f32_dpp v20, v20, v20 row_half_mirror row_mask:0xf bank_mask:0xf
    v_add_f32_dpp v21, v21, v21 row_half_mirror row_mask:0xf bank_mask:0xf
    v_add_f32_dpp v22, v22, v22 row_half_mirror row_mask:0xf bank_mask:0xf
    v_add_f32_dpp v23, v23, v23 row_half_mirror row_mask:0xf bank_mask:0xf
    v_add_f32_dpp v16, v16, v16 row_mirror row_mask:0xf bank_mask:0xf
    v_add_f32_dpp v17, v17, v17 row_mirror row_mask:0xf bank_mask:0xf
    v_add_f32_dpp v18, v18, v18 row_mirror row_mask:0xf bank_mask:0xf
    v_add_f32_dpp v19, v19, v19 row_mirror row_mask:0xf bank_mask:0xf
    v_add_f32_dpp v20, v20, v20 row_mirror row_mask:0xf bank_mask:0xf
    v_add_f32_dpp v21, v21, v21 row_mirror row_mask:0xf bank_mask:0xf
    v_add_f32_dpp v22, v22, v22 row_mirror row_mask:0xf bank_mask:0xf
    v_add_f32_dpp v23, v23, v23 row_mirror row_mask:0xf bank_mask:0xf
    v_max3_f32 v27, v16, v17, v18
    v_max3_f32 v27, v27, v19, v20
    v_max3_f32 v27, v27, v21, v22
    v_max3_f32 v24, v27, v23, v24
    v_mul_f32 v28, s28, v24
    v_sub_f32 v27, v25, v28
    v_exp_f32 v27, v27
    v_mov_b32 v25, v28
    v_fma_f32 v16, v16, s28, -v28
    v_fma_f32 v17, v17, s28, -v28
    v_fma_f32 v18, v18, s28, -v28
    v_fma_f32 v19, v19, s28, -v28
    v_fma_f32 v20, v20, s28, -v28
    v_fma_f32 v21, v21, s28, -v28
    v_fma_f32 v22, v22, s28, -v28
    v_fma_f32 v23, v23, s28, -v28
    v_exp_f32 v16, v16
    v_exp_f32 v17, v17
    v_exp_f32 v18, v18
    v_exp_f32 v19, v19
    v_exp_f32 v20, v20
    v_exp_f32 v21, v21
    v_exp_f32 v22, v22
    v_exp_f32 v23, v23
    v_mul_f32 v26, v26, v27
    v_mul_f32 v8, v8, v27
    v_mul_f32 v9, v9, v27
    v_mul_f32 v10, v10, v27
    v_mul_f32 v11, v11, v27
    v_mul_f32 v12, v12, v27
    v_mul_f32 v13, v13, v27
    v_mul_f32 v14, v14, v27
    v_mul_f32 v15, v15, v27
    v_add_f32 v26, v26, v16
    v_add_f32 v26, v26, v17
    v_add_f32 v26, v26, v18
    v_add_f32 v26, v26, v19
    v_add_f32 v26, v26, v20
    v_add_f32 v26, v26, v21
    v_add_f32 v26, v26, v22
    v_add_f32 v26, v26, v23
    s_waitcnt vmcnt(24)
    v_lshlrev_b32 v28, 16, v96
    v_and_b32 v29, s29, v96
    v_lshlrev_b32 v30, 16, v97
    v_and_b32 v31, s29, v97
    v_fmac_f32 v8, v16, v28
    v_fmac_f32 v9, v16, v29
    v_fmac_f32 v10, v16, v30
    v_fmac_f32 v11, v16, v31
    v_lshlrev_b32 v28, 16, v98
    v_and_b32 v29, s29, v98
    v_lshlrev_b32 v30, 16, v99
    v_and_b32 v31, s29, v99
    v_fmac_f32 v12, v16, v28
    v_fmac_f32 v13, v16, v29
    v_fmac_f32 v14, v16, v30
    v_fmac_f32 v15, v16, v31
    v_lshlrev_b32 v28, 16, v100
    v_and_b32 v29, s29, v100
    v_lshlrev_b32 v30, 16, v101
    v_and_b32 v31, s29, v101
    v_fmac_f32 v8, v17, v28
    v_fmac_f32 v9, v17, v29
    v_fmac_f32 v10, v17, v30
    v_fmac_f32 v11, v17, v31
    v_lshlrev_b32 v28, 16, v102
    v_and_b32 v29, s29, v102
    v_lshlrev_b32 v30, 16, v103
    v_and_b32 v31, s29, v103
    v_fmac_f32 v12, v17, v28
    v_fmac_f32 v13, v17, v29
    v_fmac_f32 v14, v17, v30
    v_fmac_f32 v15, v17, v31
    v_lshlrev_b32 v28, 16, v104
    v_and_b32 v29, s29, v104
    v_lshlrev_b32 v30, 16, v105
    v_and_b32 v31, s29, v105
    v_fmac_f32 v8, v18, v28
    v_fmac_f32 v9, v18, v29
    v_fmac_f32 v10, v18, v30
    v_fmac_f32 v11, v18, v31
    v_lshlrev_b32 v28, 16, v106
    v_and_b32 v29, s29, v106
    v_lshlrev_b32 v30, 16, v107
    v_and_b32 v31, s29, v107
    v_fmac_f32 v12, v18, v28
    v_fmac_f32 v13, v18, v29
    v_fmac_f32 v14, v18, v30
    v_fmac_f32 v15, v18, v31
    v_lshlrev_b32 v28, 16, v108
    v_and_b32 v29, s29, v108
    v_lshlrev_b32 v30, 16, v109
    v_and_b32 v31, s29, v109
    v_fmac_f32 v8, v19, v28
    v_fmac_f32 v9, v19, v29
    v_fmac_f32 v10, v19, v30
    v_fmac_f32 v11, v19, v31
    v_lshlrev_b32 v28, 16, v110
    v_and_b32 v29, s29, v110
    v_lshlrev_b32 v30, 16, v111
    v_and_b32 v31, s29, v111
    v_fmac_f32 v12, v19, v28
    v_fmac_f32 v13, v19, v29
    v_fmac_f32 v14, v19, v30
    v_fmac_f32 v15, v19, v31
    v_lshlrev_b32 v28, 16, v112
    v_and_b32 v29, s29, v112
    v_lshlrev_b32 v30, 16, v113
    v_and_b32 v31, s29, v113
    v_fmac_f32 v8, v20, v28
    v_fmac_f32 v9, v20, v29
    v_fmac_f32 v10, v20, v30
    v_fmac_f32 v11, v20, v31
    v_lshlrev_b32 v28, 16, v114
    v_and_b32 v29, s29, v114
    v_lshlrev_b32 v30, 16, v115
    v_and_b32 v31, s29, v115
    v_fmac_f32 v12, v20, v28
    v_fmac_f32 v13, v20, v29
    v_fmac_f32 v14, v20, v30
    v_fmac_f32 v15, v20, v31
    v_lshlrev_b32 v28, 16, v116
    v_and_b32 v29, s29, v116
    v_lshlrev_b32 v30, 16, v117
    v_and_b32 v31, s29, v117
    v_fmac_f32 v8, v21, v28
    v_fmac_f32 v9, v21, v29
    v_fmac_f32 v10, v21, v30
    v_fmac_f32 v11, v21, v31
    v_lshlrev_b32 v28, 16, v118
    v_and_b32 v29, s29, v118
    v_lshlrev_b32 v30, 16, v119
    v_and_b32 v31, s29, v119
    v_fmac_f32 v12, v21, v28
    v_fmac_f32 v13, v21, v29
    v_fmac_f32 v14, v21, v30
    v_fmac_f32 v15, v21, v31
    v_lshlrev_b32 v28, 16, v120
    v_and_b32 v29, s29, v120
    v_lshlrev_b32 v30, 16, v121
    v_and_b32 v31, s29, v121
    v_fmac_f32 v8, v22, v28
    v_fmac_f32 v9, v22, v29
    v_fmac_f32 v10, v22, v30
    v_fmac_f32 v11, v22, v31
    v_lshlrev_b32 v28, 16, v122
    v_and_b32 v29, s29, v122
    v_lshlrev_b32 v30, 16, v123
    v_and_b32 v31, s29, v123
    v_fmac_f32 v12, v22, v28
    v_fmac_f32 v13, v22, v29
    v_fmac_f32 v14, v22, v30
    v_fmac_f32 v15, v22, v31
    v_lshlrev_b32 v28, 16, v124
    v_and_b32 v29, s29, v124
    v_lshlrev_b32 v30, 16, v125
    v_and_b32 v31, s29, v125
    v_fmac_f32 v8, v23, v28
    v_fmac_f32 v9, v23, v29
    v_fmac_f32 v10, v23, v30
    v_fmac_f32 v11, v23, v31
    v_lshlrev_b32 v28, 16, v126
    v_and_b32 v29, s29, v126
    v_lshlrev_b32 v30, 16, v127
    v_and_b32 v31, s29, v127
    v_fmac_f32 v12, v23, v28
    v_fmac_f32 v13, v23, v29
    v_fmac_f32 v14, v23, v30
    v_fmac_f32 v15, v23, v31
    global_load_dwordx4 v[96:99], v3, s[22:23] offset:-4096 nt
    global_load_dwordx4 v[100:103], v3, s[22:23] offset:-3072 nt
    global_load_dwordx4 v[104:107], v3, s[22:23] offset:-2048 nt
    global_load_dwordx4 v[108:111], v3, s[22:23] offset:-1024 nt
    global_load_dwordx4 v[112:115], v3, s[22:23] offset:0 nt
    global_load_dwordx4 v[116:119], v3, s[22:23] offset:1024 nt
    global_load_dwordx4 v[120:123], v3, s[22:23] offset:2048 nt
    global_load_dwordx4 v[124:127], v3, s[22:23] offset:3072 nt
    s_add_u32 s22, s22, 65536
    s_addc_u32 s23, s23, 0
    s_waitcnt vmcnt(24)
    v_dot2_f32_bf16 v16, v128, v4, 0
    v_dot2_f32_bf16 v17, v132, v4, 0
    v_dot2_f32_bf16 v18, v136, v4, 0
    v_dot2_f32_bf16 v19, v140, v4, 0
    v_dot2_f32_bf16 v20, v144, v4, 0
    v_dot2_f32_bf16 v21, v148, v4, 0
    v_dot2_f32_bf16 v22, v152, v4, 0
    v_dot2_f32_bf16 v23, v156, v4, 0
    v_dot2_f32_bf16 v16, v129, v5, v16
    v_dot2_f32_bf16 v17, v133, v5, v17
    v_dot2_f32_bf16 v18, v137, v5, v18
    v_dot2_f32_bf16 v19, v141, v5, v19
    v_dot2_f32_bf16 v20, v145, v5, v20
    v_dot2_f32_bf16 v21, v149, v5, v21
    v_dot2_f32_bf16 v22, v153, v5, v22
    v_dot2_f32_bf16 v23, v157, v5, v23
    v_dot2_f32_bf16 v16, v130, v6, v16
    v_dot2_f32_bf16 v17, v134, v6, v17
    v_dot2_f32_bf16 v18, v138, v6, v18
    v_dot2_f32_bf16 v19, v142, v6, v19
    v_dot2_f32_bf16 v20, v146, v6, v20
    v_dot2_f32_bf16 v21, v150, v6, v21
    v_dot2_f32_bf16 v22, v154, v6, v22
    v_dot2_f32_bf16 v23, v158, v6, v23
    v_dot2_f32_bf16 v16, v131, v7, v16
    v_dot2_f32_bf16 v17, v135, v7, v17
    v_dot2_f32_bf16 v18, v139, v7, v18
    v_dot2_f32_bf16 v19, v143, v7, v19
    v_dot2_f32_bf16 v20, v147, v7, v20
    v_dot2_f32_bf16 v21, v151, v7, v21
    v_dot2_f32_bf16 v22, v155, v7, v22
    v_dot2_f32_bf16 v23, v159, v7, v23
    global_load_dwordx4 v[128:131], v3, s[20:21] offset:-4096 nt
    global_load_dwordx4 v[132:135], v3, s[20:21] offset:-3072 nt
    global_load_dwordx4 v[136:139], v3, s[20:21] offset:-2048 nt
    global_load_dwordx4 v[140:143], v3, s[20:21] offset:-1024 nt
    global_load_dwordx4 v[144:147], v3, s[20:21] offset:0 nt
    global_load_dwordx4 v[148:151], v3, s[20:21] offset:1024 nt
    global_load_dwordx4 v[152:155], v3, s[20:21] offset:2048 nt
    global_load_dwordx4 v[156:159], v3, s[20:21] offset:3072 nt
    s_add_u32 s20, s20, 65536
    s_addc_u32 s21, s21, 0
    v_add_f32_dpp v16, v16, v16 quad_perm:[1,0,3,2] row_mask:0xf bank_mask:0xf
    v_add_f32_dpp v17, v17, v17 quad_perm:[1,0,3,2] row_mask:0xf bank_mask:0xf
    v_add_f32_dpp v18, v18, v18 quad_perm:[1,0,3,2] row_mask:0xf bank_mask:0xf
    v_add_f32_dpp v19, v19, v19 quad_perm:[1,0,3,2] row_mask:0xf bank_mask:0xf
    v_add_f32_dpp v20, v20, v20 quad_perm:[1,0,3,2] row_mask:0xf bank_mask:0xf
    v_add_f32_dpp v21, v21, v21 quad_perm:[1,0,3,2] row_mask:0xf bank_mask:0xf
    v_add_f32_dpp v22, v22, v22 quad_perm:[1,0,3,2] row_mask:0xf bank_mask:0xf
    v_add_f32_dpp v23, v23, v23 quad_perm:[1,0,3,2] row_mask:0xf bank_mask:0xf
    v_add_f32_dpp v16, v16, v16 quad_perm:[2,3,0,1] row_mask:0xf bank_mask:0xf
    v_add_f32_dpp v17, v17, v17 quad_perm:[2,3,0,1] row_mask:0xf bank_mask:0xf
    v_add_f32_dpp v18, v18, v18 quad_perm:[2,3,0,1] row_mask:0xf bank_mask:0xf
    v_add_f32_dpp v19, v19, v19 quad_perm:[2,3,0,1] row_mask:0xf bank_mask:0xf
    v_add_f32_dpp v20, v20, v20 quad_perm:[2,3,0,1] row_mask:0xf bank_mask:0xf
    v_add_f32_dpp v21, v21, v21 quad_perm:[2,3,0,1] row_mask:0xf bank_mask:0xf
    v_add_f32_dpp v22, v22, v22 quad_perm:[2,3,0,1] row_mask:0xf bank_mask:0xf
    v_add_f32_dpp v23, v23, v23 quad_perm:[2,3,0,1] row_mask:0xf bank_mask:0xf
    v_add_f32_dpp v16, v16, v16 row_half_mirror row_mask:0xf bank_mask:0xf
    v_add_f32_dpp v17, v17, v17 row_half_mirror row_mask:0xf bank_mask:0xf
    v_add_f32_dpp v18, v18, v18 row_half_mirror row_mask:0xf bank_mask:0xf
    v_add_f32_dpp v19, v19, v19 row_half_mirror row_mask:0xf bank_mask:0xf
    v_add_f32_dpp v20, v20, v20 row_half_mirror row_mask:0xf bank_mask:0xf
    v_add_f32_dpp v21, v21, v21 row_half_mirror row_mask:0xf bank_mask:0xf
    v_add_f32_dpp v22, v22, v22 row_half_mirror row_mask:0xf bank_mask:0xf
    v_add_f32_dpp v23, v23, v23 row_half_mirror row_mask:0xf bank_mask:0xf
    v_add_f32_dpp v16, v16, v16 row_mirror row_mask:0xf bank_mask:0xf
    v_add_f32_dpp v17, v17, v17 row_mirror row_mask:0xf bank_mask:0xf
    v_add_f32_dpp v18, v18, v18 row_mirror row_mask:0xf bank_mask:0xf
    v_add_f32_dpp v19, v19, v19 row_mirror row_mask:0xf bank_mask:0xf
    v_add_f32_dpp v20, v20, v20 row_mirror row_mask:0xf bank_mask:0xf
    v_add_f32_dpp v21, v21, v21 row_mirror row_mask:0xf bank_mask:0xf
    v_add_f32_dpp v22, v22, v22 row_mirror row_mask:0xf bank_mask:0xf
    v_add_f32_dpp v23, v23, v23 row_mirror row_mask:0xf bank_mask:0xf
    v_max3_f32 v27, v16, v17, v18
    v_max3_f32 v27, v27, v19, v20
    v_max3_f32 v27, v27, v21, v22
    v_max3_f32 v24, v27, v23, v24
    v_mul_f32 v28, s28, v24
    v_sub_f32 v27, v25, v28
    v_exp_f32 v27, v27
    v_mov_b32 v25, v28
    v_fma_f32 v16, v16, s28, -v28
    v_fma_f32 v17, v17, s28, -v28
    v_fma_f32 v18, v18, s28, -v28
    v_fma_f32 v19, v19, s28, -v28
    v_fma_f32 v20, v20, s28, -v28
    v_fma_f32 v21, v21, s28, -v28
    v_fma_f32 v22, v22, s28, -v28
    v_fma_f32 v23, v23, s28, -v28
    v_exp_f32 v16, v16
    v_exp_f32 v17, v17
    v_exp_f32 v18, v18
    v_exp_f32 v19, v19
    v_exp_f32 v20, v20
    v_exp_f32 v21, v21
    v_exp_f32 v22, v22
    v_exp_f32 v23, v23
    v_mul_f32 v26, v26, v27
    v_mul_f32 v8, v8, v27
    v_mul_f32 v9, v9, v27
    v_mul_f32 v10, v10, v27
    v_mul_f32 v11, v11, v27
    v_mul_f32 v12, v12, v27
    v_mul_f32 v13, v13, v27
    v_mul_f32 v14, v14, v27
    v_mul_f32 v15, v15, v27
    v_add_f32 v26, v26, v16
    v_add_f32 v26, v26, v17
    v_add_f32 v26, v26, v18
    v_add_f32 v26, v26, v19
    v_add_f32 v26, v26, v20
    v_add_f32 v26, v26, v21
    v_add_f32 v26, v26, v22
    v_add_f32 v26, v26, v23
    s_waitcnt vmcnt(24)
    v_lshlrev_b32 v28, 16, v160
    v_and_b32 v29, s29, v160
    v_lshlrev_b32 v30, 16, v161
    v_and_b32 v31, s29, v161
    v_fmac_f32 v8, v16, v28
    v_fmac_f32 v9, v16, v29
    v_fmac_f32 v10, v16, v30
    v_fmac_f32 v11, v16, v31
    v_lshlrev_b32 v28, 16, v162
    v_and_b32 v29, s29, v162
    v_lshlrev_b32 v30, 16, v163
    v_and_b32 v31, s29, v163
    v_fmac_f32 v12, v16, v28
    v_fmac_f32 v13, v16, v29
    v_fmac_f32 v14, v16, v30
    v_fmac_f32 v15, v16, v31
    v_lshlrev_b32 v28, 16, v164
    v_and_b32 v29, s29, v164
    v_lshlrev_b32 v30, 16, v165
    v_and_b32 v31, s29, v165
    v_fmac_f32 v8, v17, v28
    v_fmac_f32 v9, v17, v29
    v_fmac_f32 v10, v17, v30
    v_fmac_f32 v11, v17, v31
    v_lshlrev_b32 v28, 16, v166
    v_and_b32 v29, s29, v166
    v_lshlrev_b32 v30, 16, v167
    v_and_b32 v31, s29, v167
    v_fmac_f32 v12, v17, v28
    v_fmac_f32 v13, v17, v29
    v_fmac_f32 v14, v17, v30
    v_fmac_f32 v15, v17, v31
    v_lshlrev_b32 v28, 16, v168
    v_and_b32 v29, s29, v168
    v_lshlrev_b32 v30, 16, v169
    v_and_b32 v31, s29, v169
    v_fmac_f32 v8, v18, v28
    v_fmac_f32 v9, v18, v29
    v_fmac_f32 v10, v18, v30
    v_fmac_f32 v11, v18, v31
    v_lshlrev_b32 v28, 16, v170
    v_and_b32 v29, s29, v170
    v_lshlrev_b32 v30, 16, v171
    v_and_b32 v31, s29, v171
    v_fmac_f32 v12, v18, v28
    v_fmac_f32 v13, v18, v29
    v_fmac_f32 v14, v18, v30
    v_fmac_f32 v15, v18, v31
    v_lshlrev_b32 v28, 16, v172
    v_and_b32 v29, s29, v172
    v_lshlrev_b32 v30, 16, v173
    v_and_b32 v31, s29, v173
    v_fmac_f32 v8, v19, v28
    v_fmac_f32 v9, v19, v29
    v_fmac_f32 v10, v19, v30
    v_fmac_f32 v11, v19, v31
    v_lshlrev_b32 v28, 16, v174
    v_and_b32 v29, s29, v174
    v_lshlrev_b32 v30, 16, v175
    v_and_b32 v31, s29, v175
    v_fmac_f32 v12, v19, v28
    v_fmac_f32 v13, v19, v29
    v_fmac_f32 v14, v19, v30
    v_fmac_f32 v15, v19, v31
    v_lshlrev_b32 v28, 16, v176
    v_and_b32 v29, s29, v176
    v_lshlrev_b32 v30, 16, v177
    v_and_b32 v31, s29, v177
    v_fmac_f32 v8, v20, v28
    v_fmac_f32 v9, v20, v29
    v_fmac_f32 v10, v20, v30
    v_fmac_f32 v11, v20, v31
    v_lshlrev_b32 v28, 16, v178
    v_and_b32 v29, s29, v178
    v_lshlrev_b32 v30, 16, v179
    v_and_b32 v31, s29, v179
    v_fmac_f32 v12, v20, v28
    v_fmac_f32 v13, v20, v29
    v_fmac_f32 v14, v20, v30
    v_fmac_f32 v15, v20, v31
    v_lshlrev_b32 v28, 16, v180
    v_and_b32 v29, s29, v180
    v_lshlrev_b32 v30, 16, v181
    v_and_b32 v31, s29, v181
    v_fmac_f32 v8, v21, v28
    v_fmac_f32 v9, v21, v29
    v_fmac_f32 v10, v21, v30
    v_fmac_f32 v11, v21, v31
    v_lshlrev_b32 v28, 16, v182
    v_and_b32 v29, s29, v182
    v_lshlrev_b32 v30, 16, v183
    v_and_b32 v31, s29, v183
    v_fmac_f32 v12, v21, v28
    v_fmac_f32 v13, v21, v29
    v_fmac_f32 v14, v21, v30
    v_fmac_f32 v15, v21, v31
    v_lshlrev_b32 v28, 16, v184
    v_and_b32 v29, s29, v184
    v_lshlrev_b32 v30, 16, v185
    v_and_b32 v31, s29, v185
    v_fmac_f32 v8, v22, v28
    v_fmac_f32 v9, v22, v29
    v_fmac_f32 v10, v22, v30
    v_fmac_f32 v11, v22, v31
    v_lshlrev_b32 v28, 16, v186
    v_and_b32 v29, s29, v186
    v_lshlrev_b32 v30, 16, v187
    v_and_b32 v31, s29, v187
    v_fmac_f32 v12, v22, v28
    v_fmac_f32 v13, v22, v29
    v_fmac_f32 v14, v22, v30
    v_fmac_f32 v15, v22, v31
    v_lshlrev_b32 v28, 16, v188
    v_and_b32 v29, s29, v188
    v_lshlrev_b32 v30, 16, v189
    v_and_b32 v31, s29, v189
    v_fmac_f32 v8, v23, v28
    v_fmac_f32 v9, v23, v29
    v_fmac_f32 v10, v23, v30
    v_fmac_f32 v11, v23, v31
    v_lshlrev_b32 v28, 16, v190
    v_and_b32 v29, s29, v190
    v_lshlrev_b32 v30, 16, v191
    v_and_b32 v31, s29, v191
    v_fmac_f32 v12, v23, v28
    v_fmac_f32 v13, v23, v29
    v_fmac_f32 v14, v23, v30
    v_fmac_f32 v15, v23, v31
    global_load_dwordx4 v[160:163], v3, s[22:23] offset:-4096 nt
    global_load_dwordx4 v[164:167], v3, s[22:23] offset:-3072 nt
    global_load_dwordx4 v[168:171], v3, s[22:23] offset:-2048 nt
    global_load_dwordx4 v[172:175], v3, s[22:23] offset:-1024 nt
    global_load_dwordx4 v[176:179], v3, s[22:23] offset:0 nt
    global_load_dwordx4 v[180:183], v3, s[22:23] offset:1024 nt
    global_load_dwordx4 v[184:187], v3, s[22:23] offset:2048 nt
    global_load_dwordx4 v[188:191], v3, s[22:23] offset:3072 nt
    s_add_u32 s22, s22, 65536
    s_addc_u32 s23, s23, 0
    s_waitcnt vmcnt(24)
    v_dot2_f32_bf16 v16, v64, v4, 0
    v_dot2_f32_bf16 v17, v68, v4, 0
    v_dot2_f32_bf16 v18, v72, v4, 0
    v_dot2_f32_bf16 v19, v76, v4, 0
    v_dot2_f32_bf16 v20, v80, v4, 0
    v_dot2_f32_bf16 v21, v84, v4, 0
    v_dot2_f32_bf16 v22, v88, v4, 0
    v_dot2_f32_bf16 v23, v92, v4, 0
    v_dot2_f32_bf16 v16, v65, v5, v16
    v_dot2_f32_bf16 v17, v69, v5, v17
    v_dot2_f32_bf16 v18, v73, v5, v18
    v_dot2_f32_bf16 v19, v77, v5, v19
    v_dot2_f32_bf16 v20, v81, v5, v20
    v_dot2_f32_bf16 v21, v85, v5, v21
    v_dot2_f32_bf16 v22, v89, v5, v22
    v_dot2_f32_bf16 v23, v93, v5, v23
    v_dot2_f32_bf16 v16, v66, v6, v16
    v_dot2_f32_bf16 v17, v70, v6, v17
    v_dot2_f32_bf16 v18, v74, v6, v18
    v_dot2_f32_bf16 v19, v78, v6, v19
    v_dot2_f32_bf16 v20, v82, v6, v20
    v_dot2_f32_bf16 v21, v86, v6, v21
    v_dot2_f32_bf16 v22, v90, v6, v22
    v_dot2_f32_bf16 v23, v94, v6, v23
    v_dot2_f32_bf16 v16, v67, v7, v16
    v_dot2_f32_bf16 v17, v71, v7, v17
    v_dot2_f32_bf16 v18, v75, v7, v18
    v_dot2_f32_bf16 v19, v79, v7, v19
    v_dot2_f32_bf16 v20, v83, v7, v20
    v_dot2_f32_bf16 v21, v87, v7, v21
    v_dot2_f32_bf16 v22, v91, v7, v22
    v_dot2_f32_bf16 v23, v95, v7, v23
    global_load_dwordx4 v[64:67], v3, s[20:21] offset:-4096 nt
    global_load_dwordx4 v[68:71], v3, s[20:21] offset:-3072 nt
    global_load_dwordx4 v[72:75], v3, s[20:21] offset:-2048 nt
    global_load_dwordx4 v[76:79], v3, s[20:21] offset:-1024 nt
    global_load_dwordx4 v[80:83], v3, s[20:21] offset:0 nt
    global_load_dwordx4 v[84:87], v3, s[20:21] offset:1024 nt
    global_load_dwordx4 v[88:91], v3, s[20:21] offset:2048 nt
    global_load_dwordx4 v[92:95], v3, s[20:21] offset:3072 nt
    s_add_u32 s20, s20, 65536
    s_addc_u32 s21, s21, 0
    v_add_f32_dpp v16, v16, v16 quad_perm:[1,0,3,2] row_mask:0xf bank_mask:0xf
    v_add_f32_dpp v17, v17, v17 quad_perm:[1,0,3,2] row_mask:0xf bank_mask:0xf
    v_add_f32_dpp v18, v18, v18 quad_perm:[1,0,3,2] row_mask:0xf bank_mask:0xf
    v_add_f32_dpp v19, v19, v19 quad_perm:[1,0,3,2] row_mask:0xf bank_mask:0xf
    v_add_f32_dpp v20, v20, v20 quad_perm:[1,0,3,2] row_mask:0xf bank_mask:0xf
    v_add_f32_dpp v21, v21, v21 quad_perm:[1,0,3,2] row_mask:0xf bank_mask:0xf
    v_add_f32_dpp v22, v22, v22 quad_perm:[1,0,3,2] row_mask:0xf bank_mask:0xf
    v_add_f32_dpp v23, v23, v23 quad_perm:[1,0,3,2] row_mask:0xf bank_mask:0xf
    v_add_f32_dpp v16, v16, v16 quad_perm:[2,3,0,1] row_mask:0xf bank_mask:0xf
    v_add_f32_dpp v17, v17, v17 quad_perm:[2,3,0,1] row_mask:0xf bank_mask:0xf
    v_add_f32_dpp v18, v18, v18 quad_perm:[2,3,0,1] row_mask:0xf bank_mask:0xf
    v_add_f32_dpp v19, v19, v19 quad_perm:[2,3,0,1] row_mask:0xf bank_mask:0xf
    v_add_f32_dpp v20, v20, v20 quad_perm:[2,3,0,1] row_mask:0xf bank_mask:0xf
    v_add_f32_dpp v21, v21, v21 quad_perm:[2,3,0,1] row_mask:0xf bank_mask:0xf
    v_add_f32_dpp v22, v22, v22 quad_perm:[2,3,0,1] row_mask:0xf bank_mask:0xf
    v_add_f32_dpp v23, v23, v23 quad_perm:[2,3,0,1] row_mask:0xf bank_mask:0xf
    v_add_f32_dpp v16, v16, v16 row_half_mirror row_mask:0xf bank_mask:0xf
    v_add_f32_dpp v17, v17, v17 row_half_mirror row_mask:0xf bank_mask:0xf
    v_add_f32_dpp v18, v18, v18 row_half_mirror row_mask:0xf bank_mask:0xf
    v_add_f32_dpp v19, v19, v19 row_half_mirror row_mask:0xf bank_mask:0xf
    v_add_f32_dpp v20, v20, v20 row_half_mirror row_mask:0xf bank_mask:0xf
    v_add_f32_dpp v21, v21, v21 row_half_mirror row_mask:0xf bank_mask:0xf
    v_add_f32_dpp v22, v22, v22 row_half_mirror row_mask:0xf bank_mask:0xf
    v_add_f32_dpp v23, v23, v23 row_half_mirror row_mask:0xf bank_mask:0xf
    v_add_f32_dpp v16, v16, v16 row_mirror row_mask:0xf bank_mask:0xf
    v_add_f32_dpp v17, v17, v17 row_mirror row_mask:0xf bank_mask:0xf
    v_add_f32_dpp v18, v18, v18 row_mirror row_mask:0xf bank_mask:0xf
    v_add_f32_dpp v19, v19, v19 row_mirror row_mask:0xf bank_mask:0xf
    v_add_f32_dpp v20, v20, v20 row_mirror row_mask:0xf bank_mask:0xf
    v_add_f32_dpp v21, v21, v21 row_mirror row_mask:0xf bank_mask:0xf
    v_add_f32_dpp v22, v22, v22 row_mirror row_mask:0xf bank_mask:0xf
    v_add_f32_dpp v23, v23, v23 row_mirror row_mask:0xf bank_mask:0xf
    v_max3_f32 v27, v16, v17, v18
    v_max3_f32 v27, v27, v19, v20
    v_max3_f32 v27, v27, v21, v22
    v_max3_f32 v24, v27, v23, v24
    v_mul_f32 v28, s28, v24
    v_sub_f32 v27, v25, v28
    v_exp_f32 v27, v27
    v_mov_b32 v25, v28
    v_fma_f32 v16, v16, s28, -v28
    v_fma_f32 v17, v17, s28, -v28
    v_fma_f32 v18, v18, s28, -v28
    v_fma_f32 v19, v19, s28, -v28
    v_fma_f32 v20, v20, s28, -v28
    v_fma_f32 v21, v21, s28, -v28
    v_fma_f32 v22, v22, s28, -v28
    v_fma_f32 v23, v23, s28, -v28
    v_exp_f32 v16, v16
    v_exp_f32 v17, v17
    v_exp_f32 v18, v18
    v_exp_f32 v19, v19
    v_exp_f32 v20, v20
    v_exp_f32 v21, v21
    v_exp_f32 v22, v22
    v_exp_f32 v23, v23
    v_mul_f32 v26, v26, v27
    v_mul_f32 v8, v8, v27
    v_mul_f32 v9, v9, v27
    v_mul_f32 v10, v10, v27
    v_mul_f32 v11, v11, v27
    v_mul_f32 v12, v12, v27
    v_mul_f32 v13, v13, v27
    v_mul_f32 v14, v14, v27
    v_mul_f32 v15, v15, v27
    v_add_f32 v26, v26, v16
    v_add_f32 v26, v26, v17
    v_add_f32 v26, v26, v18
    v_add_f32 v26, v26, v19
    v_add_f32 v26, v26, v20
    v_add_f32 v26, v26, v21
    v_add_f32 v26, v26, v22
    v_add_f32 v26, v26, v23
    s_waitcnt vmcnt(24)
    v_lshlrev_b32 v28, 16, v96
    v_and_b32 v29, s29, v96
    v_lshlrev_b32 v30, 16, v97
    v_and_b32 v31, s29, v97
    v_fmac_f32 v8, v16, v28
    v_fmac_f32 v9, v16, v29
    v_fmac_f32 v10, v16, v30
    v_fmac_f32 v11, v16, v31
    v_lshlrev_b32 v28, 16, v98
    v_and_b32 v29, s29, v98
    v_lshlrev_b32 v30, 16, v99
    v_and_b32 v31, s29, v99
    v_fmac_f32 v12, v16, v28
    v_fmac_f32 v13, v16, v29
    v_fmac_f32 v14, v16, v30
    v_fmac_f32 v15, v16, v31
    v_lshlrev_b32 v28, 16, v100
    v_and_b32 v29, s29, v100
    v_lshlrev_b32 v30, 16, v101
    v_and_b32 v31, s29, v101
    v_fmac_f32 v8, v17, v28
    v_fmac_f32 v9, v17, v29
    v_fmac_f32 v10, v17, v30
    v_fmac_f32 v11, v17, v31
    v_lshlrev_b32 v28, 16, v102
    v_and_b32 v29, s29, v102
    v_lshlrev_b32 v30, 16, v103
    v_and_b32 v31, s29, v103
    v_fmac_f32 v12, v17, v28
    v_fmac_f32 v13, v17, v29
    v_fmac_f32 v14, v17, v30
    v_fmac_f32 v15, v17, v31
    v_lshlrev_b32 v28, 16, v104
    v_and_b32 v29, s29, v104
    v_lshlrev_b32 v30, 16, v105
    v_and_b32 v31, s29, v105
    v_fmac_f32 v8, v18, v28
    v_fmac_f32 v9, v18, v29
    v_fmac_f32 v10, v18, v30
    v_fmac_f32 v11, v18, v31
    v_lshlrev_b32 v28, 16, v106
    v_and_b32 v29, s29, v106
    v_lshlrev_b32 v30, 16, v107
    v_and_b32 v31, s29, v107
    v_fmac_f32 v12, v18, v28
    v_fmac_f32 v13, v18, v29
    v_fmac_f32 v14, v18, v30
    v_fmac_f32 v15, v18, v31
    v_lshlrev_b32 v28, 16, v108
    v_and_b32 v29, s29, v108
    v_lshlrev_b32 v30, 16, v109
    v_and_b32 v31, s29, v109
    v_fmac_f32 v8, v19, v28
    v_fmac_f32 v9, v19, v29
    v_fmac_f32 v10, v19, v30
    v_fmac_f32 v11, v19, v31
    v_lshlrev_b32 v28, 16, v110
    v_and_b32 v29, s29, v110
    v_lshlrev_b32 v30, 16, v111
    v_and_b32 v31, s29, v111
    v_fmac_f32 v12, v19, v28
    v_fmac_f32 v13, v19, v29
    v_fmac_f32 v14, v19, v30
    v_fmac_f32 v15, v19, v31
    v_lshlrev_b32 v28, 16, v112
    v_and_b32 v29, s29, v112
    v_lshlrev_b32 v30, 16, v113
    v_and_b32 v31, s29, v113
    v_fmac_f32 v8, v20, v28
    v_fmac_f32 v9, v20, v29
    v_fmac_f32 v10, v20, v30
    v_fmac_f32 v11, v20, v31
    v_lshlrev_b32 v28, 16, v114
    v_and_b32 v29, s29, v114
    v_lshlrev_b32 v30, 16, v115
    v_and_b32 v31, s29, v115
    v_fmac_f32 v12, v20, v28
    v_fmac_f32 v13, v20, v29
    v_fmac_f32 v14, v20, v30
    v_fmac_f32 v15, v20, v31
    v_lshlrev_b32 v28, 16, v116
    v_and_b32 v29, s29, v116
    v_lshlrev_b32 v30, 16, v117
    v_and_b32 v31, s29, v117
    v_fmac_f32 v8, v21, v28
    v_fmac_f32 v9, v21, v29
    v_fmac_f32 v10, v21, v30
    v_fmac_f32 v11, v21, v31
    v_lshlrev_b32 v28, 16, v118
    v_and_b32 v29, s29, v118
    v_lshlrev_b32 v30, 16, v119
    v_and_b32 v31, s29, v119
    v_fmac_f32 v12, v21, v28
    v_fmac_f32 v13, v21, v29
    v_fmac_f32 v14, v21, v30
    v_fmac_f32 v15, v21, v31
    v_lshlrev_b32 v28, 16, v120
    v_and_b32 v29, s29, v120
    v_lshlrev_b32 v30, 16, v121
    v_and_b32 v31, s29, v121
    v_fmac_f32 v8, v22, v28
    v_fmac_f32 v9, v22, v29
    v_fmac_f32 v10, v22, v30
    v_fmac_f32 v11, v22, v31
    v_lshlrev_b32 v28, 16, v122
    v_and_b32 v29, s29, v122
    v_lshlrev_b32 v30, 16, v123
    v_and_b32 v31, s29, v123
    v_fmac_f32 v12, v22, v28
    v_fmac_f32 v13, v22, v29
    v_fmac_f32 v14, v22, v30
    v_fmac_f32 v15, v22, v31
    v_lshlrev_b32 v28, 16, v124
    v_and_b32 v29, s29, v124
    v_lshlrev_b32 v30, 16, v125
    v_and_b32 v31, s29, v125
    v_fmac_f32 v8, v23, v28
    v_fmac_f32 v9, v23, v29
    v_fmac_f32 v10, v23, v30
    v_fmac_f32 v11, v23, v31
    v_lshlrev_b32 v28, 16, v126
    v_and_b32 v29, s29, v126
    v_lshlrev_b32 v30, 16, v127
    v_and_b32 v31, s29, v127
    v_fmac_f32 v12, v23, v28
    v_fmac_f32 v13, v23, v29
    v_fmac_f32 v14, v23, v30
    v_fmac_f32 v15, v23, v31
    global_load_dwordx4 v[96:99], v3, s[22:23] offset:-4096 nt
    global_load_dwordx4 v[100:103], v3, s[22:23] offset:-3072 nt
    global_load_dwordx4 v[104:107], v3, s[22:23] offset:-2048 nt
    global_load_dwordx4 v[108:111], v3, s[22:23] offset:-1024 nt
    global_load_dwordx4 v[112:115], v3, s[22:23] offset:0 nt
    global_load_dwordx4 v[116:119], v3, s[22:23] offset:1024 nt
    global_load_dwordx4 v[120:123], v3, s[22:23] offset:2048 nt
    global_load_dwordx4 v[124:127], v3, s[22:23] offset:3072 nt
    s_add_u32 s22, s22, 65536
    s_addc_u32 s23, s23, 0
    s_waitcnt vmcnt(24)
    v_dot2_f32_bf16 v16, v128, v4, 0
    v_dot2_f32_bf16 v17, v132, v4, 0
    v_dot2_f32_bf16 v18, v136, v4, 0
    v_dot2_f32_bf16 v19, v140, v4, 0
    v_dot2_f32_bf16 v20, v144, v4, 0
    v_dot2_f32_bf16 v21, v148, v4, 0
    v_dot2_f32_bf16 v22, v152, v4, 0
    v_dot2_f32_bf16 v23, v156, v4, 0
    v_dot2_f32_bf16 v16, v129, v5, v16
    v_dot2_f32_bf16 v17, v133, v5, v17
    v_dot2_f32_bf16 v18, v137, v5, v18
    v_dot2_f32_bf16 v19, v141, v5, v19
    v_dot2_f32_bf16 v20, v145, v5, v20
    v_dot2_f32_bf16 v21, v149, v5, v21
    v_dot2_f32_bf16 v22, v153, v5, v22
    v_dot2_f32_bf16 v23, v157, v5, v23
    v_dot2_f32_bf16 v16, v130, v6, v16
    v_dot2_f32_bf16 v17, v134, v6, v17
    v_dot2_f32_bf16 v18, v138, v6, v18
    v_dot2_f32_bf16 v19, v142, v6, v19
    v_dot2_f32_bf16 v20, v146, v6, v20
    v_dot2_f32_bf16 v21, v150, v6, v21
    v_dot2_f32_bf16 v22, v154, v6, v22
    v_dot2_f32_bf16 v23, v158, v6, v23
    v_dot2_f32_bf16 v16, v131, v7, v16
    v_dot2_f32_bf16 v17, v135, v7, v17
    v_dot2_f32_bf16 v18, v139, v7, v18
    v_dot2_f32_bf16 v19, v143, v7, v19
    v_dot2_f32_bf16 v20, v147, v7, v20
    v_dot2_f32_bf16 v21, v151, v7, v21
    v_dot2_f32_bf16 v22, v155, v7, v22
    v_dot2_f32_bf16 v23, v159, v7, v23
    s_cmp_le_u32 s40, 7
    s_cbranch_scc1 L_i_1
    global_load_dwordx4 v[128:131], v3, s[20:21] offset:-4096 nt
    global_load_dwordx4 v[132:135], v3, s[20:21] offset:-3072 nt
    global_load_dwordx4 v[136:139], v3, s[20:21] offset:-2048 nt
    global_load_dwordx4 v[140:143], v3, s[20:21] offset:-1024 nt
    global_load_dwordx4 v[144:147], v3, s[20:21] offset:0 nt
    global_load_dwordx4 v[148:151], v3, s[20:21] offset:1024 nt
    global_load_dwordx4 v[152:155], v3, s[20:21] offset:2048 nt
    global_load_dwordx4 v[156:159], v3, s[20:21] offset:3072 nt
    s_add_u32 s20, s20, 65536
    s_addc_u32 s21, s21, 0
L_i_1:
    v_add_f32_dpp v16, v16, v16 quad_perm:[1,0,3,2] row_mask:0xf bank_mask:0xf
    v_add_f32_dpp v17, v17, v17 quad_perm:[1,0,3,2] row_mask:0xf bank_mask:0xf
    v_add_f32_dpp v18, v18, v18 quad_perm:[1,0,3,2] row_mask:0xf bank_mask:0xf
    v_add_f32_dpp v19, v19, v19 quad_perm:[1,0,3,2] row_mask:0xf bank_mask:0xf
    v_add_f32_dpp v20, v20, v20 quad_perm:[1,0,3,2] row_mask:0xf bank_mask:0xf
    v_add_f32_dpp v21, v21, v21 quad_perm:[1,0,3,2] row_mask:0xf bank_mask:0xf
    v_add_f32_dpp v22, v22, v22 quad_perm:[1,0,3,2] row_mask:0xf bank_mask:0xf
    v_add_f32_dpp v23, v23, v23 quad_perm:[1,0,3,2] row_mask:0xf bank_mask:0xf
    v_add_f32_dpp v16, v16, v16 quad_perm:[2,3,0,1] row_mask:0xf bank_mask:0xf
    v_add_f32_dpp v17, v17, v17 quad_perm:[2,3,0,1] row_mask:0xf bank_mask:0xf
    v_add_f32_dpp v18, v18, v18 quad_perm:[2,3,0,1] row_mask:0xf bank_mask:0xf
    v_add_f32_dpp v19, v19, v19 quad_perm:[2,3,0,1] row_mask:0xf bank_mask:0xf
    v_add_f32_dpp v20, v20, v20 quad_perm:[2,3,0,1] row_mask:0xf bank_mask:0xf
    v_add_f32_dpp v21, v21, v21 quad_perm:[2,3,0,1] row_mask:0xf bank_mask:0xf
    v_add_f32_dpp v22, v22, v22 quad_perm:[2,3,0,1] row_mask:0xf bank_mask:0xf
    v_add_f32_dpp v23, v23, v23 quad_perm:[2,3,0,1] row_mask:0xf bank_mask:0xf
    v_add_f32_dpp v16, v16, v16 row_half_mirror row_mask:0xf bank_mask:0xf
    v_add_f32_dpp v17, v17, v17 row_half_mirror row_mask:0xf bank_mask:0xf
    v_add_f32_dpp v18, v18, v18 row_half_mirror row_mask:0xf bank_mask:0xf
    v_add_f32_dpp v19, v19, v19 row_half_mirror row_mask:0xf bank_mask:0xf
    v_add_f32_dpp v20, v20, v20 row_half_mirror row_mask:0xf bank_mask:0xf
    v_add_f32_dpp v21, v21, v21 row_half_mirror row_mask:0xf bank_mask:0xf
    v_add_f32_dpp v22, v22, v22 row_half_mirror row_mask:0xf bank_mask:0xf
    v_add_f32_dpp v23, v23, v23 row_half_mirror row_mask:0xf bank_mask:0xf
    v_add_f32_dpp v16, v16, v16 row_mirror row_mask:0xf bank_mask:0xf
    v_add_f32_dpp v17, v17, v17 row_mirror row_mask:0xf bank_mask:0xf
    v_add_f32_dpp v18, v18, v18 row_mirror row_mask:0xf bank_mask:0xf
    v_add_f32_dpp v19, v19, v19 row_mirror row_mask:0xf bank_mask:0xf
    v_add_f32_dpp v20, v20, v20 row_mirror row_mask:0xf bank_mask:0xf
    v_add_f32_dpp v21, v21, v21 row_mirror row_mask:0xf bank_mask:0xf
    v_add_f32_dpp v22, v22, v22 row_mirror row_mask:0xf bank_mask:0xf
    v_add_f32_dpp v23, v23, v23 row_mirror row_mask:0xf bank_mask:0xf
    v_max3_f32 v27, v16, v17, v18
    v_max3_f32 v27, v27, v19, v20
    v_max3_f32 v27, v27, v21, v22
    v_max3_f32 v24, v27, v23, v24
    v_mul_f32 v28, s28, v24
    v_sub_f32 v27, v25, v28
    v_exp_f32 v27, v27
    v_mov_b32 v25, v28
    v_fma_f32 v16, v16, s28, -v28
    v_fma_f32 v17, v17, s28, -v28
    v_fma_f32 v18, v18, s28, -v28
    v_fma_f32 v19, v19, s28, -v28
    v_fma_f32 v20, v20, s28, -v28
    v_fma_f32 v21, v21, s28, -v28
    v_fma_f32 v22, v22, s28, -v28
    v_fma_f32 v23, v23, s28, -v28
    v_exp_f32 v16, v16
    v_exp_f32 v17, v17
    v_exp_f32 v18, v18
    v_exp_f32 v19, v19
    v_exp_f32 v20, v20
    v_exp_f32 v21, v21
    v_exp_f32 v22, v22
    v_exp_f32 v23, v23
    v_mul_f32 v26, v26, v27
    v_mul_f32 v8, v8, v27
    v_mul_f32 v9, v9, v27
    v_mul_f32 v10, v10, v27
    v_mul_f32 v11, v11, v27
    v_mul_f32 v12, v12, v27
    v_mul_f32 v13, v13, v27
    v_mul_f32 v14, v14, v27
    v_mul_f32 v15, v15, v27
    v_add_f32 v26, v26, v16
    v_add_f32 v26, v26, v17
    v_add_f32 v26, v26, v18
    v_add_f32 v26, v26, v19
    v_add_f32 v26, v26, v20
    v_add_f32 v26, v26, v21
    v_add_f32 v26, v26, v22
    v_add_f32 v26, v26, v23
    s_cmp_gt_u32 s40, 7
    s_cbranch_scc1 L_w_2
    s_waitcnt vmcnt(16)
L_w_2:
    s_waitcnt vmcnt(24)
    v_lshlrev_b32 v28, 16, v160
    v_and_b32 v29, s29, v160
    v_lshlrev_b32 v30, 16, v161
    v_and_b32 v31, s29, v161
    v_fmac_f32 v8, v16, v28
    v_fmac_f32 v9, v16, v29
    v_fmac_f32 v10, v16, v30
    v_fmac_f32 v11, v16, v31
    v_lshlrev_b32 v28, 16, v162
    v_and_b32 v29, s29, v162
    v_lshlrev_b32 v30, 16, v163
    v_and_b32 v31, s29, v163
    v_fmac_f32 v12, v16, v28
    v_fmac_f32 v13, v16, v29
    v_fmac_f32 v14, v16, v30
    v_fmac_f32 v15, v16, v31
    v_lshlrev_b32 v28, 16, v164
    v_and_b32 v29, s29, v164
    v_lshlrev_b32 v30, 16, v165
    v_and_b32 v31, s29, v165
    v_fmac_f32 v8, v17, v28
    v_fmac_f32 v9, v17, v29
    v_fmac_f32 v10, v17, v30
    v_fmac_f32 v11, v17, v31
    v_lshlrev_b32 v28, 16, v166
    v_and_b32 v29, s29, v166
    v_lshlrev_b32 v30, 16, v167
    v_and_b32 v31, s29, v167
    v_fmac_f32 v12, v17, v28
    v_fmac_f32 v13, v17, v29
    v_fmac_f32 v14, v17, v30
    v_fmac_f32 v15, v17, v31
    v_lshlrev_b32 v28, 16, v168
    v_and_b32 v29, s29, v168
    v_lshlrev_b32 v30, 16, v169
    v_and_b32 v31, s29, v169
    v_fmac_f32 v8, v18, v28
    v_fmac_f32 v9, v18, v29
    v_fmac_f32 v10, v18, v30
    v_fmac_f32 v11, v18, v31
    v_lshlrev_b32 v28, 16, v170
    v_and_b32 v29, s29, v170
    v_lshlrev_b32 v30, 16, v171
    v_and_b32 v31, s29, v171
    v_fmac_f32 v12, v18, v28
    v_fmac_f32 v13, v18, v29
    v_fmac_f32 v14, v18, v30
    v_fmac_f32 v15, v18, v31
    v_lshlrev_b32 v28, 16, v172
    v_and_b32 v29, s29, v172
    v_lshlrev_b32 v30, 16, v173
    v_and_b32 v31, s29, v173
    v_fmac_f32 v8, v19, v28
    v_fmac_f32 v9, v19, v29
    v_fmac_f32 v10, v19, v30
    v_fmac_f32 v11, v19, v31
    v_lshlrev_b32 v28, 16, v174
    v_and_b32 v29, s29, v174
    v_lshlrev_b32 v30, 16, v175
    v_and_b32 v31, s29, v175
    v_fmac_f32 v12, v19, v28
    v_fmac_f32 v13, v19, v29
    v_fmac_f32 v14, v19, v30
    v_fmac_f32 v15, v19, v31
    v_lshlrev_b32 v28, 16, v176
    v_and_b32 v29, s29, v176
    v_lshlrev_b32 v30, 16, v177
    v_and_b32 v31, s29, v177
    v_fmac_f32 v8, v20, v28
    v_fmac_f32 v9, v20, v29
    v_fmac_f32 v10, v20, v30
    v_fmac_f32 v11, v20, v31
    v_lshlrev_b32 v28, 16, v178
    v_and_b32 v29, s29, v178
    v_lshlrev_b32 v30, 16, v179
    v_and_b32 v31, s29, v179
    v_fmac_f32 v12, v20, v28
    v_fmac_f32 v13, v20, v29
    v_fmac_f32 v14, v20, v30
    v_fmac_f32 v15, v20, v31
    v_lshlrev_b32 v28, 16, v180
    v_and_b32 v29, s29, v180
    v_lshlrev_b32 v30, 16, v181
    v_and_b32 v31, s29, v181
    v_fmac_f32 v8, v21, v28
    v_fmac_f32 v9, v21, v29
    v_fmac_f32 v10, v21, v30
    v_fmac_f32 v11, v21, v31
    v_lshlrev_b32 v28, 16, v182
    v_and_b32 v29, s29, v182
    v_lshlrev_b32 v30, 16, v183
    v_and_b32 v31, s29, v183
    v_fmac_f32 v12, v21, v28
    v_fmac_f32 v13, v21, v29
    v_fmac_f32 v14, v21, v30
    v_fmac_f32 v15, v21, v31
    v_lshlrev_b32 v28, 16, v184
    v_and_b32 v29, s29, v184
    v_lshlrev_b32 v30, 16, v185
    v_and_b32 v31, s29, v185
    v_fmac_f32 v8, v22, v28
    v_fmac_f32 v9, v22, v29
    v_fmac_f32 v10, v22, v30
    v_fmac_f32 v11, v22, v31
    v_lshlrev_b32 v28, 16, v186
    v_and_b32 v29, s29, v186
    v_lshlrev_b32 v30, 16, v187
    v_and_b32 v31, s29, v187
    v_fmac_f32 v12, v22, v28
    v_fmac_f32 v13, v22, v29
    v_fmac_f32 v14, v22, v30
    v_fmac_f32 v15, v22, v31
    v_lshlrev_b32 v28, 16, v188
    v_and_b32 v29, s29, v188
    v_lshlrev_b32 v30, 16, v189
    v_and_b32 v31, s29, v189
    v_fmac_f32 v8, v23, v28
    v_fmac_f32 v9, v23, v29
    v_fmac_f32 v10, v23, v30
    v_fmac_f32 v11, v23, v31
    v_lshlrev_b32 v28, 16, v190
    v_and_b32 v29, s29, v190
    v_lshlrev_b32 v30, 16, v191
    v_and_b32 v31, s29, v191
    v_fmac_f32 v12, v23, v28
    v_fmac_f32 v13, v23, v29
    v_fmac_f32 v14, v23, v30
    v_fmac_f32 v15, v23, v31
    s_cmp_le_u32 s40, 7
    s_cbranch_scc1 L_i_3
    global_load_dwordx4 v[160:163], v3, s[22:23] offset:-4096 nt
    global_load_dwordx4 v[164:167], v3, s[22:23] offset:-3072 nt
    global_load_dwordx4 v[168:171], v3, s[22:23] offset:-2048 nt
    global_load_dwordx4 v[172:175], v3, s[22:23] offset:-1024 nt
    global_load_dwordx4 v[176:179], v3, s[22:23] offset:0 nt
    global_load_dwordx4 v[180:183], v3, s[22:23] offset:1024 nt
    global_load_dwordx4 v[184:187], v3, s[22:23] offset:2048 nt
    global_load_dwordx4 v[188:191], v3, s[22:23] offset:3072 nt
    s_add_u32 s22, s22, 65536
    s_addc_u32 s23, s23, 0
L_i_3:
    s_cmp_gt_u32 s40, 7
    s_cbranch_scc1 L_w_4
    s_waitcnt vmcnt(8)
L_w_4:
    s_waitcnt vmcnt(24)
    v_dot2_f32_bf16 v16, v64, v4, 0
    v_dot2_f32_bf16 v17, v68, v4, 0
    v_dot2_f32_bf16 v18, v72, v4, 0
    v_dot2_f32_bf16 v19, v76, v4, 0
    v_dot2_f32_bf16 v20, v80, v4, 0
    v_dot2_f32_bf16 v21, v84, v4, 0
    v_dot2_f32_bf16 v22, v88, v4, 0
    v_dot2_f32_bf16 v23, v92, v4, 0
    v_dot2_f32_bf16 v16, v65, v5, v16
    v_dot2_f32_bf16 v17, v69, v5, v17
    v_dot2_f32_bf16 v18, v73, v5, v18
    v_dot2_f32_bf16 v19, v77, v5, v19
    v_dot2_f32_bf16 v20, v81, v5, v20
    v_dot2_f32_bf16 v21, v85, v5, v21
    v_dot2_f32_bf16 v22, v89, v5, v22
    v_dot2_f32_bf16 v23, v93, v5, v23
    v_dot2_f32_bf16 v16, v66, v6, v16
    v_dot2_f32_bf16 v17, v70, v6, v17
    v_dot2_f32_bf16 v18, v74, v6, v18
    v_dot2_f32_bf16 v19, v78, v6, v19
    v_dot2_f32_bf16 v20, v82, v6, v20
    v_dot2_f32_bf16 v21, v86, v6, v21
    v_dot2_f32_bf16 v22, v90, v6, v22
    v_dot2_f32_bf16 v23, v94, v6, v23
    v_dot2_f32_bf16 v16, v67, v7, v16
    v_dot2_f32_bf16 v17, v71, v7, v17
    v_dot2_f32_bf16 v18, v75, v7, v18
    v_dot2_f32_bf16 v19, v79, v7, v19
    v_dot2_f32_bf16 v20, v83, v7, v20
    v_dot2_f32_bf16 v21, v87, v7, v21
    v_dot2_f32_bf16 v22, v91, v7, v22
    v_dot2_f32_bf16 v23, v95, v7, v23
    s_cmp_le_u32 s40, 8
    s_cbranch_scc1 L_i_5
    global_load_dwordx4 v[64:67], v3, s[20:21] offset:-4096 nt
    global_load_dwordx4 v[68:71], v3, s[20:21] offset:-3072 nt
    global_load_dwordx4 v[72:75], v3, s[20:21] offset:-2048 nt
    global_load_dwordx4 v[76:79], v3, s[20:21] offset:-1024 nt
    global_load_dwordx4 v[80:83], v3, s[20:21] offset:0 nt
    global_load_dwordx4 v[84:87], v3, s[20:21] offset:1024 nt
    global_load_dwordx4 v[88:91], v3, s[20:21] offset:2048 nt
    global_load_dwordx4 v[92:95], v3, s[20:21] offset:3072 nt
    s_add_u32 s20, s20, 65536
    s_addc_u32 s21, s21, 0
L_i_5:
    v_add_f32_dpp v16, v16, v16 quad_perm:[1,0,3,2] row_mask:0xf bank_mask:0xf
    v_add_f32_dpp v17, v17, v17 quad_perm:[1,0,3,2] row_mask:0xf bank_mask:0xf
    v_add_f32_dpp v18, v18, v18 quad_perm:[1,0,3,2] row_mask:0xf bank_mask:0xf
    v_add_f32_dpp v19, v19, v19 quad_perm:[1,0,3,2] row_mask:0xf bank_mask:0xf
    v_add_f32_dpp v20, v20, v20 quad_perm:[1,0,3,2] row_mask:0xf bank_mask:0xf
    v_add_f32_dpp v21, v21, v21 quad_perm:[1,0,3,2] row_mask:0xf bank_mask:0xf
    v_add_f32_dpp v22, v22, v22 quad_perm:[1,0,3,2] row_mask:0xf bank_mask:0xf
    v_add_f32_dpp v23, v23, v23 quad_perm:[1,0,3,2] row_mask:0xf bank_mask:0xf
    v_add_f32_dpp v16, v16, v16 quad_perm:[2,3,0,1] row_mask:0xf bank_mask:0xf
    v_add_f32_dpp v17, v17, v17 quad_perm:[2,3,0,1] row_mask:0xf bank_mask:0xf
    v_add_f32_dpp v18, v18, v18 quad_perm:[2,3,0,1] row_mask:0xf bank_mask:0xf
    v_add_f32_dpp v19, v19, v19 quad_perm:[2,3,0,1] row_mask:0xf bank_mask:0xf
    v_add_f32_dpp v20, v20, v20 quad_perm:[2,3,0,1] row_mask:0xf bank_mask:0xf
    v_add_f32_dpp v21, v21, v21 quad_perm:[2,3,0,1] row_mask:0xf bank_mask:0xf
    v_add_f32_dpp v22, v22, v22 quad_perm:[2,3,0,1] row_mask:0xf bank_mask:0xf
    v_add_f32_dpp v23, v23, v23 quad_perm:[2,3,0,1] row_mask:0xf bank_mask:0xf
    v_add_f32_dpp v16, v16, v16 row_half_mirror row_mask:0xf bank_mask:0xf
    v_add_f32_dpp v17, v17, v17 row_half_mirror row_mask:0xf bank_mask:0xf
    v_add_f32_dpp v18, v18, v18 row_half_mirror row_mask:0xf bank_mask:0xf
    v_add_f32_dpp v19, v19, v19 row_half_mirror row_mask:0xf bank_mask:0xf
    v_add_f32_dpp v20, v20, v20 row_half_mirror row_mask:0xf bank_mask:0xf
    v_add_f32_dpp v21, v21, v21 row_half_mirror row_mask:0xf bank_mask:0xf
    v_add_f32_dpp v22, v22, v22 row_half_mirror row_mask:0xf bank_mask:0xf
    v_add_f32_dpp v23, v23, v23 row_half_mirror row_mask:0xf bank_mask:0xf
    v_add_f32_dpp v16, v16, v16 row_mirror row_mask:0xf bank_mask:0xf
    v_add_f32_dpp v17, v17, v17 row_mirror row_mask:0xf bank_mask:0xf
    v_add_f32_dpp v18, v18, v18 row_mirror row_mask:0xf bank_mask:0xf
    v_add_f32_dpp v19, v19, v19 row_mirror row_mask:0xf bank_mask:0xf
    v_add_f32_dpp v20, v20, v20 row_mirror row_mask:0xf bank_mask:0xf
    v_add_f32_dpp v21, v21, v21 row_mirror row_mask:0xf bank_mask:0xf
    v_add_f32_dpp v22, v22, v22 row_mirror row_mask:0xf bank_mask:0xf
    v_add_f32_dpp v23, v23, v23 row_mirror row_mask:0xf bank_mask:0xf
    v_max3_f32 v27, v16, v17, v18
    v_max3_f32 v27, v27, v19, v20
    v_max3_f32 v27, v27, v21, v22
    v_max3_f32 v24, v27, v23, v24
    v_mul_f32 v28, s28, v24
    v_sub_f32 v27, v25, v28
    v_exp_f32 v27, v27
    v_mov_b32 v25, v28
    v_fma_f32 v16, v16, s28, -v28
    v_fma_f32 v17, v17, s28, -v28
    v_fma_f32 v18, v18, s28, -v28
    v_fma_f32 v19, v19, s28, -v28
    v_fma_f32 v20, v20, s28, -v28
    v_fma_f32 v21, v21, s28, -v28
    v_fma_f32 v22, v22, s28, -v28
    v_fma_f32 v23, v23, s28, -v28
    v_exp_f32 v16, v16
    v_exp_f32 v17, v17
    v_exp_f32 v18, v18
    v_exp_f32 v19, v19
    v_exp_f32 v20, v20
    v_exp_f32 v21, v21
    v_exp_f32 v22, v22
    v_exp_f32 v23, v23
    v_mul_f32 v26, v26, v27
    v_mul_f32 v8, v8, v27
    v_mul_f32 v9, v9, v27
    v_mul_f32 v10, v10, v27
    v_mul_f32 v11, v11, v27
    v_mul_f32 v12, v12, v27
    v_mul_f32 v13, v13, v27
    v_mul_f32 v14, v14, v27
    v_mul_f32 v15, v15, v27
    v_add_f32 v26, v26, v16
    v_add_f32 v26, v26, v17
    v_add_f32 v26, v26, v18
    v_add_f32 v26, v26, v19
    v_add_f32 v26, v26, v20
    v_add_f32 v26, v26, v21
    v_add_f32 v26, v26, v22
    v_add_f32 v26, v26, v23
    s_cmp_gt_u32 s40, 7
    s_cbranch_scc1 L_w_6
    s_waitcnt vmcnt(0)
L_w_6:
    s_cmp_gt_u32 s40, 8
    s_cbranch_scc1 L_w_7
    s_waitcnt vmcnt(16)
L_w_7:
    s_waitcnt vmcnt(24)
    v_lshlrev_b32 v28, 16, v96
    v_and_b32 v29, s29, v96
    v_lshlrev_b32 v30, 16, v97
    v_and_b32 v31, s29, v97
    v_fmac_f32 v8, v16, v28
    v_fmac_f32 v9, v16, v29
    v_fmac_f32 v10, v16, v30
    v_fmac_f32 v11, v16, v31
    v_lshlrev_b32 v28, 16, v98
    v_and_b32 v29, s29, v98
    v_lshlrev_b32 v30, 16, v99
    v_and_b32 v31, s29, v99
    v_fmac_f32 v12, v16, v28
    v_fmac_f32 v13, v16, v29
    v_fmac_f32 v14, v16, v30
    v_fmac_f32 v15, v16, v31
    v_lshlrev_b32 v28, 16, v100
    v_and_b32 v29, s29, v100
    v_lshlrev_b32 v30, 16, v101
    v_and_b32 v31, s29, v101
    v_fmac_f32 v8, v17, v28
    v_fmac_f32 v9, v17, v29
    v_fmac_f32 v10, v17, v30
    v_fmac_f32 v11, v17, v31
    v_lshlrev_b32 v28, 16, v102
    v_and_b32 v29, s29, v102
    v_lshlrev_b32 v30, 16, v103
    v_and_b32 v31, s29, v103
    v_fmac_f32 v12, v17, v28
    v_fmac_f32 v13, v17, v29
    v_fmac_f32 v14, v17, v30
    v_fmac_f32 v15, v17, v31
    v_lshlrev_b32 v28, 16, v104
    v_and_b32 v29, s29, v104
    v_lshlrev_b32 v30, 16, v105
    v_and_b32 v31, s29, v105
    v_fmac_f32 v8, v18, v28
    v_fmac_f32 v9, v18, v29
    v_fmac_f32 v10, v18, v30
    v_fmac_f32 v11, v18, v31
    v_lshlrev_b32 v28, 16, v106
    v_and_b32 v29, s29, v106
    v_lshlrev_b32 v30, 16, v107
    v_and_b32 v31, s29, v107
    v_fmac_f32 v12, v18, v28
    v_fmac_f32 v13, v18, v29
    v_fmac_f32 v14, v18, v30
    v_fmac_f32 v15, v18, v31
    v_lshlrev_b32 v28, 16, v108
    v_and_b32 v29, s29, v108
    v_lshlrev_b32 v30, 16, v109
    v_and_b32 v31, s29, v109
    v_fmac_f32 v8, v19, v28
    v_fmac_f32 v9, v19, v29
    v_fmac_f32 v10, v19, v30
    v_fmac_f32 v11, v19, v31
    v_lshlrev_b32 v28, 16, v110
    v_and_b32 v29, s29, v110
    v_lshlrev_b32 v30, 16, v111
    v_and_b32 v31, s29, v111
    v_fmac_f32 v12, v19, v28
    v_fmac_f32 v13, v19, v29
    v_fmac_f32 v14, v19, v30
    v_fmac_f32 v15, v19, v31
    v_lshlrev_b32 v28, 16, v112
    v_and_b32 v29, s29, v112
    v_lshlrev_b32 v30, 16, v113
    v_and_b32 v31, s29, v113
    v_fmac_f32 v8, v20, v28
    v_fmac_f32 v9, v20, v29
    v_fmac_f32 v10, v20, v30
    v_fmac_f32 v11, v20, v31
    v_lshlrev_b32 v28, 16, v114
    v_and_b32 v29, s29, v114
    v_lshlrev_b32 v30, 16, v115
    v_and_b32 v31, s29, v115
    v_fmac_f32 v12, v20, v28
    v_fmac_f32 v13, v20, v29
    v_fmac_f32 v14, v20, v30
    v_fmac_f32 v15, v20, v31
    v_lshlrev_b32 v28, 16, v116
    v_and_b32 v29, s29, v116
    v_lshlrev_b32 v30, 16, v117
    v_and_b32 v31, s29, v117
    v_fmac_f32 v8, v21, v28
    v_fmac_f32 v9, v21, v29
    v_fmac_f32 v10, v21, v30
    v_fmac_f32 v11, v21, v31
    v_lshlrev_b32 v28, 16, v118
    v_and_b32 v29, s29, v118
    v_lshlrev_b32 v30, 16, v119
    v_and_b32 v31, s29, v119
    v_fmac_f32 v12, v21, v28
    v_fmac_f32 v13, v21, v29
    v_fmac_f32 v14, v21, v30
    v_fmac_f32 v15, v21, v31
    v_lshlrev_b32 v28, 16, v120
    v_and_b32 v29, s29, v120
    v_lshlrev_b32 v30, 16, v121
    v_and_b32 v31, s29, v121
    v_fmac_f32 v8, v22, v28
    v_fmac_f32 v9, v22, v29
    v_fmac_f32 v10, v22, v30
    v_fmac_f32 v11, v22, v31
    v_lshlrev_b32 v28, 16, v122
    v_and_b32 v29, s29, v122
    v_lshlrev_b32 v30, 16, v123
    v_and_b32 v31, s29, v123
    v_fmac_f32 v12, v22, v28
    v_fmac_f32 v13, v22, v29
    v_fmac_f32 v14, v22, v30
    v_fmac_f32 v15, v22, v31
    v_lshlrev_b32 v28, 16, v124
    v_and_b32 v29, s29, v124
    v_lshlrev_b32 v30, 16, v125
    v_and_b32 v31, s29, v125
    v_fmac_f32 v8, v23, v28
    v_fmac_f32 v9, v23, v29
    v_fmac_f32 v10, v23, v30
    v_fmac_f32 v11, v23, v31
    v_lshlrev_b32 v28, 16, v126
    v_and_b32 v29, s29, v126
    v_lshlrev_b32 v30, 16, v127
    v_and_b32 v31, s29, v127
    v_fmac_f32 v12, v23, v28
    v_fmac_f32 v13, v23, v29
    v_fmac_f32 v14, v23, v30
    v_fmac_f32 v15, v23, v31
    s_cmp_le_u32 s40, 8
    s_cbranch_scc1 L_i_8
    global_load_dwordx4 v[96:99], v3, s[22:23] offset:-4096 nt
    global_load_dwordx4 v[100:103], v3, s[22:23] offset:-3072 nt
    global_load_dwordx4 v[104:107], v3, s[22:23] offset:-2048 nt
    global_load_dwordx4 v[108:111], v3, s[22:23] offset:-1024 nt
    global_load_dwordx4 v[112:115], v3, s[22:23] offset:0 nt
    global_load_dwordx4 v[116:119], v3, s[22:23] offset:1024 nt
    global_load_dwordx4 v[120:123], v3, s[22:23] offset:2048 nt
    global_load_dwordx4 v[124:127], v3, s[22:23] offset:3072 nt
    s_add_u32 s22, s22, 65536
    s_addc_u32 s23, s23, 0
L_i_8:
    s_cmp_le_u32 s40, 7
    s_cbranch_scc1 L_epi
    s_cmp_gt_u32 s40, 8
    s_cbranch_scc1 L_w_9
    s_waitcnt vmcnt(8)
L_w_9:
    s_waitcnt vmcnt(24)
    v_dot2_f32_bf16 v16, v128, v4, 0
    v_dot2_f32_bf16 v17, v132, v4, 0
    v_dot2_f32_bf16 v18, v136, v4, 0
    v_dot2_f32_bf16 v19, v140, v4, 0
    v_dot2_f32_bf16 v20, v144, v4, 0
    v_dot2_f32_bf16 v21, v148, v4, 0
    v_dot2_f32_bf16 v22, v152, v4, 0
    v_dot2_f32_bf16 v23, v156, v4, 0
    v_dot2_f32_bf16 v16, v129, v5, v16
    v_dot2_f32_bf16 v17, v133, v5, v17
    v_dot2_f32_bf16 v18, v137, v5, v18
    v_dot2_f32_bf16 v19, v141, v5, v19
    v_dot2_f32_bf16 v20, v145, v5, v20
    v_dot2_f32_bf16 v21, v149, v5, v21
    v_dot2_f32_bf16 v22, v153, v5, v22
    v_dot2_f32_bf16 v23, v157, v5, v23
    v_dot2_f32_bf16 v16, v130, v6, v16
    v_dot2_f32_bf16 v17, v134, v6, v17
    v_dot2_f32_bf16 v18, v138, v6, v18
    v_dot2_f32_bf16 v19, v142, v6, v19
    v_dot2_f32_bf16 v20, v146, v6, v20
    v_dot2_f32_bf16 v21, v150, v6, v21
    v_dot2_f32_bf16 v22, v154, v6, v22
    v_dot2_f32_bf16 v23, v158, v6, v23
    v_dot2_f32_bf16 v16, v131, v7, v16
    v_dot2_f32_bf16 v17, v135, v7, v17
    v_dot2_f32_bf16 v18, v139, v7, v18
    v_dot2_f32_bf16 v19, v143, v7, v19
    v_dot2_f32_bf16 v20, v147, v7, v20
    v_dot2_f32_bf16 v21, v151, v7, v21
    v_dot2_f32_bf16 v22, v155, v7, v22
    v_dot2_f32_bf16 v23, v159, v7, v23
    v_add_f32_dpp v16, v16, v16 quad_perm:[1,0,3,2] row_mask:0xf bank_mask:0xf
    v_add_f32_dpp v17, v17, v17 quad_perm:[1,0,3,2] row_mask:0xf bank_mask:0xf
    v_add_f32_dpp v18, v18, v18 quad_perm:[1,0,3,2] row_mask:0xf bank_mask:0xf
    v_add_f32_dpp v19, v19, v19 quad_perm:[1,0,3,2] row_mask:0xf bank_mask:0xf
    v_add_f32_dpp v20, v20, v20 quad_perm:[1,0,3,2] row_mask:0xf bank_mask:0xf
    v_add_f32_dpp v21, v21, v21 quad_perm:[1,0,3,2] row_mask:0xf bank_mask:0xf
    v_add_f32_dpp v22, v22, v22 quad_perm:[1,0,3,2] row_mask:0xf bank_mask:0xf
    v_add_f32_dpp v23, v23, v23 quad_perm:[1,0,3,2] row_mask:0xf bank_mask:0xf
    v_add_f32_dpp v16, v16, v16 quad_perm:[2,3,0,1] row_mask:0xf bank_mask:0xf
    v_add_f32_dpp v17, v17, v17 quad_perm:[2,3,0,1] row_mask:0xf bank_mask:0xf
    v_add_f32_dpp v18, v18, v18 quad_perm:[2,3,0,1] row_mask:0xf bank_mask:0xf
    v_add_f32_dpp v19, v19, v19 quad_perm:[2,3,0,1] row_mask:0xf bank_mask:0xf
    v_add_f32_dpp v20, v20, v20 quad_perm:[2,3,0,1] row_mask:0xf bank_mask:0xf
    v_add_f32_dpp v21, v21, v21 quad_perm:[2,3,0,1] row_mask:0xf bank_mask:0xf
    v_add_f32_dpp v22, v22, v22 quad_perm:[2,3,0,1] row_mask:0xf bank_mask:0xf
    v_add_f32_dpp v23, v23, v23 quad_perm:[2,3,0,1] row_mask:0xf bank_mask:0xf
    v_add_f32_dpp v16, v16, v16 row_half_mirror row_mask:0xf bank_mask:0xf
    v_add_f32_dpp v17, v17, v17 row_half_mirror row_mask:0xf bank_mask:0xf
    v_add_f32_dpp v18, v18, v18 row_half_mirror row_mask:0xf bank_mask:0xf
    v_add_f32_dpp v19, v19, v19 row_half_mirror row_mask:0xf bank_mask:0xf
    v_add_f32_dpp v20, v20, v20 row_half_mirror row_mask:0xf bank_mask:0xf
    v_add_f32_dpp v21, v21, v21 row_half_mirror row_mask:0xf bank_mask:0xf
    v_add_f32_dpp v22, v22, v22 row_half_mirror row_mask:0xf bank_mask:0xf
    v_add_f32_dpp v23, v23, v23 row_half_mirror row_mask:0xf bank_mask:0xf
    v_add_f32_dpp v16, v16, v16 row_mirror row_mask:0xf bank_mask:0xf
    v_add_f32_dpp v17, v17, v17 row_mirror row_mask:0xf bank_mask:0xf
    v_add_f32_dpp v18, v18, v18 row_mirror row_mask:0xf bank_mask:0xf
    v_add_f32_dpp v19, v19, v19 row_mirror row_mask:0xf bank_mask:0xf
    v_add_f32_dpp v20, v20, v20 row_mirror row_mask:0xf bank_mask:0xf
    v_add_f32_dpp v21, v21, v21 row_mirror row_mask:0xf bank_mask:0xf
    v_add_f32_dpp v22, v22, v22 row_mirror row_mask:0xf bank_mask:0xf
    v_add_f32_dpp v23, v23, v23 row_mirror row_mask:0xf bank_mask:0xf
    v_max3_f32 v27, v16, v17, v18
    v_max3_f32 v27, v27, v19, v20
    v_max3_f32 v27, v27, v21, v22
    v_max3_f32 v24, v27, v23, v24
    v_mul_f32 v28, s28, v24
    v_sub_f32 v27, v25, v28
    v_exp_f32 v27, v27
    v_mov_b32 v25, v28
    v_fma_f32 v16, v16, s28, -v28
    v_fma_f32 v17, v17, s28, -v28
    v_fma_f32 v18, v18, s28, -v28
    v_fma_f32 v19, v19, s28, -v28
    v_fma_f32 v20, v20, s28, -v28
    v_fma_f32 v21, v21, s28, -v28
    v_fma_f32 v22, v22, s28, -v28
    v_fma_f32 v23, v23, s28, -v28
    v_exp_f32 v16, v16
    v_exp_f32 v17, v17
    v_exp_f32 v18, v18
    v_exp_f32 v19, v19
    v_exp_f32 v20, v20
    v_exp_f32 v21, v21
    v_exp_f32 v22, v22
    v_exp_f32 v23, v23
    v_mul_f32 v26, v26, v27
    v_mul_f32 v8, v8, v27
    v_mul_f32 v9, v9, v27
    v_mul_f32 v10, v10, v27
    v_mul_f32 v11, v11, v27
    v_mul_f32 v12, v12, v27
    v_mul_f32 v13, v13, v27
    v_mul_f32 v14, v14, v27
    v_mul_f32 v15, v15, v27
    v_add_f32 v26, v26, v16
    v_add_f32 v26, v26, v17
    v_add_f32 v26, v26, v18
    v_add_f32 v26, v26, v19
    v_add_f32 v26, v26, v20
    v_add_f32 v26, v26, v21
    v_add_f32 v26, v26, v22
    v_add_f32 v26, v26, v23
    s_cmp_gt_u32 s40, 8
    s_cbranch_scc1 L_w_10
    s_waitcnt vmcnt(0)
L_w_10:
    s_waitcnt vmcnt(16)
    v_lshlrev_b32 v28, 16, v160
    v_and_b32 v29, s29, v160
    v_lshlrev_b32 v30, 16, v161
    v_and_b32 v31, s29, v161
    v_fmac_f32 v8, v16, v28
    v_fmac_f32 v9, v16, v29
    v_fmac_f32 v10, v16, v30
    v_fmac_f32 v11, v16, v31
    v_lshlrev_b32 v28, 16, v162
    v_and_b32 v29, s29, v162
    v_lshlrev_b32 v30, 16, v163
    v_and_b32 v31, s29, v163
    v_fmac_f32 v12, v16, v28
    v_fmac_f32 v13, v16, v29
    v_fmac_f32 v14, v16, v30
    v_fmac_f32 v15, v16, v31
    v_lshlrev_b32 v28, 16, v164
    v_and_b32 v29, s29, v164
    v_lshlrev_b32 v30, 16, v165
    v_and_b32 v31, s29, v165
    v_fmac_f32 v8, v17, v28
    v_fmac_f32 v9, v17, v29
    v_fmac_f32 v10, v17, v30
    v_fmac_f32 v11, v17, v31
    v_lshlrev_b32 v28, 16, v166
    v_and_b32 v29, s29, v166
    v_lshlrev_b32 v30, 16, v167
    v_and_b32 v31, s29, v167
    v_fmac_f32 v12, v17, v28
    v_fmac_f32 v13, v17, v29
    v_fmac_f32 v14, v17, v30
    v_fmac_f32 v15, v17, v31
    v_lshlrev_b32 v28, 16, v168
    v_and_b32 v29, s29, v168
    v_lshlrev_b32 v30, 16, v169
    v_and_b32 v31, s29, v169
    v_fmac_f32 v8, v18, v28
    v_fmac_f32 v9, v18, v29
    v_fmac_f32 v10, v18, v30
    v_fmac_f32 v11, v18, v31
    v_lshlrev_b32 v28, 16, v170
    v_and_b32 v29, s29, v170
    v_lshlrev_b32 v30, 16, v171
    v_and_b32 v31, s29, v171
    v_fmac_f32 v12, v18, v28
    v_fmac_f32 v13, v18, v29
    v_fmac_f32 v14, v18, v30
    v_fmac_f32 v15, v18, v31
    v_lshlrev_b32 v28, 16, v172
    v_and_b32 v29, s29, v172
    v_lshlrev_b32 v30, 16, v173
    v_and_b32 v31, s29, v173
    v_fmac_f32 v8, v19, v28
    v_fmac_f32 v9, v19, v29
    v_fmac_f32 v10, v19, v30
    v_fmac_f32 v11, v19, v31
    v_lshlrev_b32 v28, 16, v174
    v_and_b32 v29, s29, v174
    v_lshlrev_b32 v30, 16, v175
    v_and_b32 v31, s29, v175
    v_fmac_f32 v12, v19, v28
    v_fmac_f32 v13, v19, v29
    v_fmac_f32 v14, v19, v30
    v_fmac_f32 v15, v19, v31
    v_lshlrev_b32 v28, 16, v176
    v_and_b32 v29, s29, v176
    v_lshlrev_b32 v30, 16, v177
    v_and_b32 v31, s29, v177
    v_fmac_f32 v8, v20, v28
    v_fmac_f32 v9, v20, v29
    v_fmac_f32 v10, v20, v30
    v_fmac_f32 v11, v20, v31
    v_lshlrev_b32 v28, 16, v178
    v_and_b32 v29, s29, v178
    v_lshlrev_b32 v30, 16, v179
    v_and_b32 v31, s29, v179
    v_fmac_f32 v12, v20, v28
    v_fmac_f32 v13, v20, v29
    v_fmac_f32 v14, v20, v30
    v_fmac_f32 v15, v20, v31
    v_lshlrev_b32 v28, 16, v180
    v_and_b32 v29, s29, v180
    v_lshlrev_b32 v30, 16, v181
    v_and_b32 v31, s29, v181
    v_fmac_f32 v8, v21, v28
    v_fmac_f32 v9, v21, v29
    v_fmac_f32 v10, v21, v30
    v_fmac_f32 v11, v21, v31
    v_lshlrev_b32 v28, 16, v182
    v_and_b32 v29, s29, v182
    v_lshlrev_b32 v30, 16, v183
    v_and_b32 v31, s29, v183
    v_fmac_f32 v12, v21, v28
    v_fmac_f32 v13, v21, v29
    v_fmac_f32 v14, v21, v30
    v_fmac_f32 v15, v21, v31
    v_lshlrev_b32 v28, 16, v184
    v_and_b32 v29, s29, v184
    v_lshlrev_b32 v30, 16, v185
    v_and_b32 v31, s29, v185
    v_fmac_f32 v8, v22, v28
    v_fmac_f32 v9, v22, v29
    v_fmac_f32 v10, v22, v30
    v_fmac_f32 v11, v22, v31
    v_lshlrev_b32 v28, 16, v186
    v_and_b32 v29, s29, v186
    v_lshlrev_b32 v30, 16, v187
    v_and_b32 v31, s29, v187
    v_fmac_f32 v12, v22, v28
    v_fmac_f32 v13, v22, v29
    v_fmac_f32 v14, v22, v30
    v_fmac_f32 v15, v22, v31
    v_lshlrev_b32 v28, 16, v188
    v_and_b32 v29, s29, v188
    v_lshlrev_b32 v30, 16, v189
    v_and_b32 v31, s29, v189
    v_fmac_f32 v8, v23, v28
    v_fmac_f32 v9, v23, v29
    v_fmac_f32 v10, v23, v30
    v_fmac_f32 v11, v23, v31
    v_lshlrev_b32 v28, 16, v190
    v_and_b32 v29, s29, v190
    v_lshlrev_b32 v30, 16, v191
    v_and_b32 v31, s29, v191
    v_fmac_f32 v12, v23, v28
    v_fmac_f32 v13, v23, v29
    v_fmac_f32 v14, v23, v30
    v_fmac_f32 v15, v23, v31
    s_cmp_le_u32 s40, 8
    s_cbranch_scc1 L_epi
    s_waitcnt vmcnt(8)
    v_dot2_f32_bf16 v16, v64, v4, 0
    v_dot2_f32_bf16 v17, v68, v4, 0
    v_dot2_f32_bf16 v18, v72, v4, 0
    v_dot2_f32_bf16 v19, v76, v4, 0
    v_dot2_f32_bf16 v20, v80, v4, 0
    v_dot2_f32_bf16 v21, v84, v4, 0
    v_dot2_f32_bf16 v22, v88, v4, 0
    v_dot2_f32_bf16 v23, v92, v4, 0
    v_dot2_f32_bf16 v16, v65, v5, v16
    v_dot2_f32_bf16 v17, v69, v5, v17
    v_dot2_f32_bf16 v18, v73, v5, v18
    v_dot2_f32_bf16 v19, v77, v5, v19
    v_dot2_f32_bf16 v20, v81, v5, v20
    v_dot2_f32_bf16 v21, v85, v5, v21
    v_dot2_f32_bf16 v22, v89, v5, v22
    v_dot2_f32_bf16 v23, v93, v5, v23
    v_dot2_f32_bf16 v16, v66, v6, v16
    v_dot2_f32_bf16 v17, v70, v6, v17
    v_dot2_f32_bf16 v18, v74, v6, v18
    v_dot2_f32_bf16 v19, v78, v6, v19
    v_dot2_f32_bf16 v20, v82, v6, v20
    v_dot2_f32_bf16 v21, v86, v6, v21
    v_dot2_f32_bf16 v22, v90, v6, v22
    v_dot2_f32_bf16 v23, v94, v6, v23
    v_dot2_f32_bf16 v16, v67, v7, v16
    v_dot2_f32_bf16 v17, v71, v7, v17
    v_dot2_f32_bf16 v18, v75, v7, v18
    v_dot2_f32_bf16 v19, v79, v7, v19
    v_dot2_f32_bf16 v20, v83, v7, v20
    v_dot2_f32_bf16 v21, v87, v7, v21
    v_dot2_f32_bf16 v22, v91, v7, v22
    v_dot2_f32_bf16 v23, v95, v7, v23
    v_add_f32_dpp v16, v16, v16 quad_perm:[1,0,3,2] row_mask:0xf bank_mask:0xf
    v_add_f32_dpp v17, v17, v17 quad_perm:[1,0,3,2] row_mask:0xf bank_mask:0xf
    v_add_f32_dpp v18, v18, v18 quad_perm:[1,0,3,2] row_mask:0xf bank_mask:0xf
    v_add_f32_dpp v19, v19, v19 quad_perm:[1,0,3,2] row_mask:0xf bank_mask:0xf
    v_add_f32_dpp v20, v20, v20 quad_perm:[1,0,3,2] row_mask:0xf bank_mask:0xf
    v_add_f32_dpp v21, v21, v21 quad_perm:[1,0,3,2] row_mask:0xf bank_mask:0xf
    v_add_f32_dpp v22, v22, v22 quad_perm:[1,0,3,2] row_mask:0xf bank_mask:0xf
    v_add_f32_dpp v23, v23, v23 quad_perm:[1,0,3,2] row_mask:0xf bank_mask:0xf
    v_add_f32_dpp v16, v16, v16 quad_perm:[2,3,0,1] row_mask:0xf bank_mask:0xf
    v_add_f32_dpp v17, v17, v17 quad_perm:[2,3,0,1] row_mask:0xf bank_mask:0xf
    v_add_f32_dpp v18, v18, v18 quad_perm:[2,3,0,1] row_mask:0xf bank_mask:0xf
    v_add_f32_dpp v19, v19, v19 quad_perm:[2,3,0,1] row_mask:0xf bank_mask:0xf
    v_add_f32_dpp v20, v20, v20 quad_perm:[2,3,0,1] row_mask:0xf bank_mask:0xf
    v_add_f32_dpp v21, v21, v21 quad_perm:[2,3,0,1] row_mask:0xf bank_mask:0xf
    v_add_f32_dpp v22, v22, v22 quad_perm:[2,3,0,1] row_mask:0xf bank_mask:0xf
    v_add_f32_dpp v23, v23, v23 quad_perm:[2,3,0,1] row_mask:0xf bank_mask:0xf
    v_add_f32_dpp v16, v16, v16 row_half_mirror row_mask:0xf bank_mask:0xf
    v_add_f32_dpp v17, v17, v17 row_half_mirror row_mask:0xf bank_mask:0xf
    v_add_f32_dpp v18, v18, v18 row_half_mirror row_mask:0xf bank_mask:0xf
    v_add_f32_dpp v19, v19, v19 row_half_mirror row_mask:0xf bank_mask:0xf
    v_add_f32_dpp v20, v20, v20 row_half_mirror row_mask:0xf bank_mask:0xf
    v_add_f32_dpp v21, v21, v21 row_half_mirror row_mask:0xf bank_mask:0xf
    v_add_f32_dpp v22, v22, v22 row_half_mirror row_mask:0xf bank_mask:0xf
    v_add_f32_dpp v23, v23, v23 row_half_mirror row_mask:0xf bank_mask:0xf
    v_add_f32_dpp v16, v16, v16 row_mirror row_mask:0xf bank_mask:0xf
    v_add_f32_dpp v17, v17, v17 row_mirror row_mask:0xf bank_mask:0xf
    v_add_f32_dpp v18, v18, v18 row_mirror row_mask:0xf bank_mask:0xf
    v_add_f32_dpp v19, v19, v19 row_mirror row_mask:0xf bank_mask:0xf
    v_add_f32_dpp v20, v20, v20 row_mirror row_mask:0xf bank_mask:0xf
    v_add_f32_dpp v21, v21, v21 row_mirror row_mask:0xf bank_mask:0xf
    v_add_f32_dpp v22, v22, v22 row_mirror row_mask:0xf bank_mask:0xf
    v_add_f32_dpp v23, v23, v23 row_mirror row_mask:0xf bank_mask:0xf
    v_max3_f32 v27, v16, v17, v18
    v_max3_f32 v27, v27, v19, v20
    v_max3_f32 v27, v27, v21, v22
    v_max3_f32 v24, v27, v23, v24
    v_mul_f32 v28, s28, v24
    v_sub_f32 v27, v25, v28
    v_exp_f32 v27, v27
    v_mov_b32 v25, v28
    v_fma_f32 v16, v16, s28, -v28
    v_fma_f32 v17, v17, s28, -v28
    v_fma_f32 v18, v18, s28, -v28
    v_fma_f32 v19, v19, s28, -v28
    v_fma_f32 v20, v20, s28, -v28
    v_fma_f32 v21, v21, s28, -v28
    v_fma_f32 v22, v22, s28, -v28
    v_fma_f32 v23, v23, s28, -v28
    v_exp_f32 v16, v16
    v_exp_f32 v17, v17
    v_exp_f32 v18, v18
    v_exp_f32 v19, v19
    v_exp_f32 v20, v20
    v_exp_f32 v21, v21
    v_exp_f32 v22, v22
    v_exp_f32 v23, v23
    v_mul_f32 v26, v26, v27
    v_mul_f32 v8, v8, v27
    v_mul_f32 v9, v9, v27
    v_mul_f32 v10, v10, v27
    v_mul_f32 v11, v11, v27
    v_mul_f32 v12, v12, v27
    v_mul_f32 v13, v13, v27
    v_mul_f32 v14, v14, v27
    v_mul_f32 v15, v15, v27
    v_add_f32 v26, v26, v16
    v_add_f32 v26, v26, v17
    v_add_f32 v26, v26, v18
    v_add_f32 v26, v26, v19
    v_add_f32 v26, v26, v20
    v_add_f32 v26, v26, v21
    v_add_f32 v26, v26, v22
    v_add_f32 v26, v26, v23
    s_waitcnt vmcnt(0)
    v_lshlrev_b32 v28, 16, v96
    v_and_b32 v29, s29, v96
    v_lshlrev_b32 v30, 16, v97
    v_and_b32 v31, s29, v97
    v_fmac_f32 v8, v16, v28
    v_fmac_f32 v9, v16, v29
    v_fmac_f32 v10, v16, v30
    v_fmac_f32 v11, v16, v31
    v_lshlrev_b32 v28, 16, v98
    v_and_b32 v29, s29, v98
    v_lshlrev_b32 v30, 16, v99
    v_and_b32 v31, s29, v99
    v_fmac_f32 v12, v16, v28
    v_fmac_f32 v13, v16, v29
    v_fmac_f32 v14, v16, v30
    v_fmac_f32 v15, v16, v31
    v_lshlrev_b32 v28, 16, v100
    v_and_b32 v29, s29, v100
    v_lshlrev_b32 v30, 16, v101
    v_and_b32 v31, s29, v101
    v_fmac_f32 v8, v17, v28
    v_fmac_f32 v9, v17, v29
    v_fmac_f32 v10, v17, v30
    v_fmac_f32 v11, v17, v31
    v_lshlrev_b32 v28, 16, v102
    v_and_b32 v29, s29, v102
    v_lshlrev_b32 v30, 16, v103
    v_and_b32 v31, s29, v103
    v_fmac_f32 v12, v17, v28
    v_fmac_f32 v13, v17, v29
    v_fmac_f32 v14, v17, v30
    v_fmac_f32 v15, v17, v31
    v_lshlrev_b32 v28, 16, v104
    v_and_b32 v29, s29, v104
    v_lshlrev_b32 v30, 16, v105
    v_and_b32 v31, s29, v105
    v_fmac_f32 v8, v18, v28
    v_fmac_f32 v9, v18, v29
    v_fmac_f32 v10, v18, v30
    v_fmac_f32 v11, v18, v31
    v_lshlrev_b32 v28, 16, v106
    v_and_b32 v29, s29, v106
    v_lshlrev_b32 v30, 16, v107
    v_and_b32 v31, s29, v107
    v_fmac_f32 v12, v18, v28
    v_fmac_f32 v13, v18, v29
    v_fmac_f32 v14, v18, v30
    v_fmac_f32 v15, v18, v31
    v_lshlrev_b32 v28, 16, v108
    v_and_b32 v29, s29, v108
    v_lshlrev_b32 v30, 16, v109
    v_and_b32 v31, s29, v109
    v_fmac_f32 v8, v19, v28
    v_fmac_f32 v9, v19, v29
    v_fmac_f32 v10, v19, v30
    v_fmac_f32 v11, v19, v31
    v_lshlrev_b32 v28, 16, v110
    v_and_b32 v29, s29, v110
    v_lshlrev_b32 v30, 16, v111
    v_and_b32 v31, s29, v111
    v_fmac_f32 v12, v19, v28
    v_fmac_f32 v13, v19, v29
    v_fmac_f32 v14, v19, v30
    v_fmac_f32 v15, v19, v31
    v_lshlrev_b32 v28, 16, v112
    v_and_b32 v29, s29, v112
    v_lshlrev_b32 v30, 16, v113
    v_and_b32 v31, s29, v113
    v_fmac_f32 v8, v20, v28
    v_fmac_f32 v9, v20, v29
    v_fmac_f32 v10, v20, v30
    v_fmac_f32 v11, v20, v31
    v_lshlrev_b32 v28, 16, v114
    v_and_b32 v29, s29, v114
    v_lshlrev_b32 v30, 16, v115
    v_and_b32 v31, s29, v115
    v_fmac_f32 v12, v20, v28
    v_fmac_f32 v13, v20, v29
    v_fmac_f32 v14, v20, v30
    v_fmac_f32 v15, v20, v31
    v_lshlrev_b32 v28, 16, v116
    v_and_b32 v29, s29, v116
    v_lshlrev_b32 v30, 16, v117
    v_and_b32 v31, s29, v117
    v_fmac_f32 v8, v21, v28
    v_fmac_f32 v9, v21, v29
    v_fmac_f32 v10, v21, v30
    v_fmac_f32 v11, v21, v31
    v_lshlrev_b32 v28, 16, v118
    v_and_b32 v29, s29, v118
    v_lshlrev_b32 v30, 16, v119
    v_and_b32 v31, s29, v119
    v_fmac_f32 v12, v21, v28
    v_fmac_f32 v13, v21, v29
    v_fmac_f32 v14, v21, v30
    v_fmac_f32 v15, v21, v31
    v_lshlrev_b32 v28, 16, v120
    v_and_b32 v29, s29, v120
    v_lshlrev_b32 v30, 16, v121
    v_and_b32 v31, s29, v121
    v_fmac_f32 v8, v22, v28
    v_fmac_f32 v9, v22, v29
    v_fmac_f32 v10, v22, v30
    v_fmac_f32 v11, v22, v31
    v_lshlrev_b32 v28, 16, v122
    v_and_b32 v29, s29, v122
    v_lshlrev_b32 v30, 16, v123
    v_and_b32 v31, s29, v123
    v_fmac_f32 v12, v22, v28
    v_fmac_f32 v13, v22, v29
    v_fmac_f32 v14, v22, v30
    v_fmac_f32 v15, v22, v31
    v_lshlrev_b32 v28, 16, v124
    v_and_b32 v29, s29, v124
    v_lshlrev_b32 v30, 16, v125
    v_and_b32 v31, s29, v125
    v_fmac_f32 v8, v23, v28
    v_fmac_f32 v9, v23, v29
    v_fmac_f32 v10, v23, v30
    v_fmac_f32 v11, v23, v31
    v_lshlrev_b32 v28, 16, v126
    v_and_b32 v29, s29, v126
    v_lshlrev_b32 v30, 16, v127
    v_and_b32 v31, s29, v127
    v_fmac_f32 v12, v23, v28
    v_fmac_f32 v13, v23, v29
    v_fmac_f32 v14, v23, v30
    v_fmac_f32 v15, v23, v31
L_epi:
    v_lshrrev_b32 v28, 4, v1
    v_and_b32 v29, 15, v1
    v_lshlrev_b32 v30, 2, v28
    s_lshl_b32 s36, s19, 4
    v_add_u32 v30, s36, v30
    ds_write_b32 v30, v25 offset:4096
    ds_write_b32 v30, v26 offset:4224
    v_lshlrev_b32 v31, 7, v30
    v_lshl_add_u32 v31, v29, 5, v31
    ds_write_b128 v31, v[8:11] offset:4352
    ds_write_b128 v31, v[12:15] offset:4368
    v_and_b32 v30, 7, v29
    v_lshrrev_b32 v31, 3, v29
    v_lshl_add_u32 v30, v31, 6, v30
    s_lshl_b32 s36, s19, 3
    v_add_u32 v30, s36, v30
    v_lshlrev_b32 v30, 2, v30
    v_lshl_add_u32 v30, v28, 12, v30
    v_lshlrev_b32 v31, 5, v28
    v_mov_b32 v8, 0
    v_mov_b32 v9, 0
    v_mov_b32 v10, 0
    v_mov_b32 v11, 0
    v_mov_b32 v12, 0
    v_mov_b32 v13, 0
    v_mov_b32 v14, 0
    v_mov_b32 v15, 0
    s_waitcnt lgkmcnt(0)
    s_barrier
    ds_read_b128 v[32:35], v31 offset:4096
    ds_read_b128 v[36:39], v31 offset:4112
    ds_read_b32 v40, v30 offset:4352
    ds_read_b32 v41, v30 offset:4864
    ds_read_b32 v42, v30 offset:5376
    ds_read_b32 v43, v30 offset:5888
    ds_read_b32 v44, v30 offset:6400
    ds_read_b32 v45, v30 offset:6912
    ds_read_b32 v46, v30 offset:7424
    ds_read_b32 v47, v30 offset:7936
    ds_read_b128 v[48:51], v31 offset:4224
    ds_read_b128 v[52:55], v31 offset:4240
    s_waitcnt lgkmcnt(10)
    v_max3_f32 v16, v32, v33, v34
    v_max3_f32 v16, v16, v35, v36
    v_max3_f32 v16, v16, v37, v38
    v_max_f32 v16, v16, v39
    v_mov_b32 v17, v16
    s_nop 1
    v_permlane32_swap_b32 v16, v17
    s_nop 0
    v_max_f32 v16, v16, v17
    v_mov_b32 v17, v16
    s_nop 1
    v_permlane16_swap_b32 v16, v17
    s_nop 0
    v_max_f32 v16, v16, v17
    v_sub_f32 v32, v32, v16
    v_sub_f32 v33, v33, v16
    v_sub_f32 v34, v34, v16
    v_sub_f32 v35, v35, v16
    v_sub_f32 v36, v36, v16
    v_sub_f32 v37, v37, v16
    v_sub_f32 v38, v38, v16
    v_sub_f32 v39, v39, v16
    v_exp_f32 v32, v32
    v_exp_f32 v33, v33
    v_exp_f32 v34, v34
    v_exp_f32 v35, v35
    v_exp_f32 v36, v36
    v_exp_f32 v37, v37
    v_exp_f32 v38, v38
    v_exp_f32 v39, v39
    s_waitcnt lgkmcnt(2)
    v_mul_f32 v17, v32, v40
    v_fmac_f32 v17, v33, v41
    v_fmac_f32 v17, v34, v42
    v_fmac_f32 v17, v35, v43
    v_fmac_f32 v17, v36, v44
    v_fmac_f32 v17, v37, v45
    v_fmac_f32 v17, v38, v46
    v_fmac_f32 v17, v39, v47
    v_mov_b32 v18, v17
    s_nop 1
    v_permlane32_swap_b32 v17, v18
    s_nop 0
    v_add_f32 v17, v17, v18
    v_mov_b32 v18, v17
    s_nop 1
    v_permlane16_swap_b32 v17, v18
    s_nop 0
    v_add_f32 v17, v17, v18
    v_cvt_pk_bf16_f32 v18, v17, 0
    v_lshlrev_b32 v19, 16, v18
    s_waitcnt vmcnt(0)
    s_nop 0
    v_dot2c_f32_bf16_dpp v8, v18, v192 row_newbcast:0 row_mask:0xf bank_mask:0xf
    v_dot2c_f32_bf16_dpp v9, v19, v192 row_newbcast:0 row_mask:0xf bank_mask:0xf
    v_dot2c_f32_bf16_dpp v10, v18, v193 row_newbcast:0 row_mask:0xf bank_mask:0xf
    v_dot2c_f32_bf16_dpp v11, v19, v193 row_newbcast:0 row_mask:0xf bank_mask:0xf
    v_dot2c_f32_bf16_dpp v12, v18, v194 row_newbcast:0 row_mask:0xf bank_mask:0xf
    v_dot2c_f32_bf16_dpp v13, v19, v194 row_newbcast:0 row_mask:0xf bank_mask:0xf
    v_dot2c_f32_bf16_dpp v14, v18, v195 row_newbcast:0 row_mask:0xf bank_mask:0xf
    v_dot2c_f32_bf16_dpp v15, v19, v195 row_newbcast:0 row_mask:0xf bank_mask:0xf
    v_dot2c_f32_bf16_dpp v8, v18, v196 row_newbcast:1 row_mask:0xf bank_mask:0xf
    v_dot2c_f32_bf16_dpp v9, v19, v196 row_newbcast:1 row_mask:0xf bank_mask:0xf
    v_dot2c_f32_bf16_dpp v10, v18, v197 row_newbcast:1 row_mask:0xf bank_mask:0xf
    v_dot2c_f32_bf16_dpp v11, v19, v197 row_newbcast:1 row_mask:0xf bank_mask:0xf
    v_dot2c_f32_bf16_dpp v12, v18, v198 row_newbcast:1 row_mask:0xf bank_mask:0xf
    v_dot2c_f32_bf16_dpp v13, v19, v198 row_newbcast:1 row_mask:0xf bank_mask:0xf
    v_dot2c_f32_bf16_dpp v14, v18, v199 row_newbcast:1 row_mask:0xf bank_mask:0xf
    v_dot2c_f32_bf16_dpp v15, v19, v199 row_newbcast:1 row_mask:0xf bank_mask:0xf
    v_dot2c_f32_bf16_dpp v8, v18, v200 row_newbcast:2 row_mask:0xf bank_mask:0xf
    v_dot2c_f32_bf16_dpp v9, v19, v200 row_newbcast:2 row_mask:0xf bank_mask:0xf
    v_dot2c_f32_bf16_dpp v10, v18, v201 row_newbcast:2 row_mask:0xf bank_mask:0xf
    v_dot2c_f32_bf16_dpp v11, v19, v201 row_newbcast:2 row_mask:0xf bank_mask:0xf
    v_dot2c_f32_bf16_dpp v12, v18, v202 row_newbcast:2 row_mask:0xf bank_mask:0xf
    v_dot2c_f32_bf16_dpp v13, v19, v202 row_newbcast:2 row_mask:0xf bank_mask:0xf
    v_dot2c_f32_bf16_dpp v14, v18, v203 row_newbcast:2 row_mask:0xf bank_mask:0xf
    v_dot2c_f32_bf16_dpp v15, v19, v203 row_newbcast:2 row_mask:0xf bank_mask:0xf
    v_dot2c_f32_bf16_dpp v8, v18, v204 row_newbcast:3 row_mask:0xf bank_mask:0xf
    v_dot2c_f32_bf16_dpp v9, v19, v204 row_newbcast:3 row_mask:0xf bank_mask:0xf
    v_dot2c_f32_bf16_dpp v10, v18, v205 row_newbcast:3 row_mask:0xf bank_mask:0xf
    v_dot2c_f32_bf16_dpp v11, v19, v205 row_newbcast:3 row_mask:0xf bank_mask:0xf
    v_dot2c_f32_bf16_dpp v12, v18, v206 row_newbcast:3 row_mask:0xf bank_mask:0xf
    v_dot2c_f32_bf16_dpp v13, v19, v206 row_newbcast:3 row_mask:0xf bank_mask:0xf
    v_dot2c_f32_bf16_dpp v14, v18, v207 row_newbcast:3 row_mask:0xf bank_mask:0xf
    v_dot2c_f32_bf16_dpp v15, v19, v207 row_newbcast:3 row_mask:0xf bank_mask:0xf
    v_dot2c_f32_bf16_dpp v8, v18, v208 row_newbcast:4 row_mask:0xf bank_mask:0xf
    v_dot2c_f32_bf16_dpp v9, v19, v208 row_newbcast:4 row_mask:0xf bank_mask:0xf
    v_dot2c_f32_bf16_dpp v10, v18, v209 row_newbcast:4 row_mask:0xf bank_mask:0xf
    v_dot2c_f32_bf16_dpp v11, v19, v209 row_newbcast:4 row_mask:0xf bank_mask:0xf
    v_dot2c_f32_bf16_dpp v12, v18, v210 row_newbcast:4 row_mask:0xf bank_mask:0xf
    v_dot2c_f32_bf16_dpp v13, v19, v210 row_newbcast:4 row_mask:0xf bank_mask:0xf
    v_dot2c_f32_bf16_dpp v14, v18, v211 row_newbcast:4 row_mask:0xf bank_mask:0xf
    v_dot2c_f32_bf16_dpp v15, v19, v211 row_newbcast:4 row_mask:0xf bank_mask:0xf
    v_dot2c_f32_bf16_dpp v8, v18, v212 row_newbcast:5 row_mask:0xf bank_mask:0xf
    v_dot2c_f32_bf16_dpp v9, v19, v212 row_newbcast:5 row_mask:0xf bank_mask:0xf
    v_dot2c_f32_bf16_dpp v10, v18, v213 row_newbcast:5 row_mask:0xf bank_mask:0xf
    v_dot2c_f32_bf16_dpp v11, v19, v213 row_newbcast:5 row_mask:0xf bank_mask:0xf
    v_dot2c_f32_bf16_dpp v12, v18, v214 row_newbcast:5 row_mask:0xf bank_mask:0xf
    v_dot2c_f32_bf16_dpp v13, v19, v214 row_newbcast:5 row_mask:0xf bank_mask:0xf
    v_dot2c_f32_bf16_dpp v14, v18, v215 row_newbcast:5 row_mask:0xf bank_mask:0xf
    v_dot2c_f32_bf16_dpp v15, v19, v215 row_newbcast:5 row_mask:0xf bank_mask:0xf
    v_dot2c_f32_bf16_dpp v8, v18, v216 row_newbcast:6 row_mask:0xf bank_mask:0xf
    v_dot2c_f32_bf16_dpp v9, v19, v216 row_newbcast:6 row_mask:0xf bank_mask:0xf
    v_dot2c_f32_bf16_dpp v10, v18, v217 row_newbcast:6 row_mask:0xf bank_mask:0xf
    v_dot2c_f32_bf16_dpp v11, v19, v217 row_newbcast:6 row_mask:0xf bank_mask:0xf
    v_dot2c_f32_bf16_dpp v12, v18, v218 row_newbcast:6 row_mask:0xf bank_mask:0xf
    v_dot2c_f32_bf16_dpp v13, v19, v218 row_newbcast:6 row_mask:0xf bank_mask:0xf
    v_dot2c_f32_bf16_dpp v14, v18, v219 row_newbcast:6 row_mask:0xf bank_mask:0xf
    v_dot2c_f32_bf16_dpp v15, v19, v219 row_newbcast:6 row_mask:0xf bank_mask:0xf
    v_dot2c_f32_bf16_dpp v8, v18, v220 row_newbcast:7 row_mask:0xf bank_mask:0xf
    v_dot2c_f32_bf16_dpp v9, v19, v220 row_newbcast:7 row_mask:0xf bank_mask:0xf
    v_dot2c_f32_bf16_dpp v10, v18, v221 row_newbcast:7 row_mask:0xf bank_mask:0xf
    v_dot2c_f32_bf16_dpp v11, v19, v221 row_newbcast:7 row_mask:0xf bank_mask:0xf
    v_dot2c_f32_bf16_dpp v12, v18, v222 row_newbcast:7 row_mask:0xf bank_mask:0xf
    v_dot2c_f32_bf16_dpp v13, v19, v222 row_newbcast:7 row_mask:0xf bank_mask:0xf
    v_dot2c_f32_bf16_dpp v14, v18, v223 row_newbcast:7 row_mask:0xf bank_mask:0xf
    v_dot2c_f32_bf16_dpp v15, v19, v223 row_newbcast:7 row_mask:0xf bank_mask:0xf
    v_dot2c_f32_bf16_dpp v8, v18, v224 row_newbcast:8 row_mask:0xf bank_mask:0xf
    v_dot2c_f32_bf16_dpp v9, v19, v224 row_newbcast:8 row_mask:0xf bank_mask:0xf
    v_dot2c_f32_bf16_dpp v10, v18, v225 row_newbcast:8 row_mask:0xf bank_mask:0xf
    v_dot2c_f32_bf16_dpp v11, v19, v225 row_newbcast:8 row_mask:0xf bank_mask:0xf
    v_dot2c_f32_bf16_dpp v12, v18, v226 row_newbcast:8 row_mask:0xf bank_mask:0xf
    v_dot2c_f32_bf16_dpp v13, v19, v226 row_newbcast:8 row_mask:0xf bank_mask:0xf
    v_dot2c_f32_bf16_dpp v14, v18, v227 row_newbcast:8 row_mask:0xf bank_mask:0xf
    v_dot2c_f32_bf16_dpp v15, v19, v227 row_newbcast:8 row_mask:0xf bank_mask:0xf
    v_dot2c_f32_bf16_dpp v8, v18, v228 row_newbcast:9 row_mask:0xf bank_mask:0xf
    v_dot2c_f32_bf16_dpp v9, v19, v228 row_newbcast:9 row_mask:0xf bank_mask:0xf
    v_dot2c_f32_bf16_dpp v10, v18, v229 row_newbcast:9 row_mask:0xf bank_mask:0xf
    v_dot2c_f32_bf16_dpp v11, v19, v229 row_newbcast:9 row_mask:0xf bank_mask:0xf
    v_dot2c_f32_bf16_dpp v12, v18, v230 row_newbcast:9 row_mask:0xf bank_mask:0xf
    v_dot2c_f32_bf16_dpp v13, v19, v230 row_newbcast:9 row_mask:0xf bank_mask:0xf
    v_dot2c_f32_bf16_dpp v14, v18, v231 row_newbcast:9 row_mask:0xf bank_mask:0xf
    v_dot2c_f32_bf16_dpp v15, v19, v231 row_newbcast:9 row_mask:0xf bank_mask:0xf
    v_dot2c_f32_bf16_dpp v8, v18, v232 row_newbcast:10 row_mask:0xf bank_mask:0xf
    v_dot2c_f32_bf16_dpp v9, v19, v232 row_newbcast:10 row_mask:0xf bank_mask:0xf
    v_dot2c_f32_bf16_dpp v10, v18, v233 row_newbcast:10 row_mask:0xf bank_mask:0xf
    v_dot2c_f32_bf16_dpp v11, v19, v233 row_newbcast:10 row_mask:0xf bank_mask:0xf
    v_dot2c_f32_bf16_dpp v12, v18, v234 row_newbcast:10 row_mask:0xf bank_mask:0xf
    v_dot2c_f32_bf16_dpp v13, v19, v234 row_newbcast:10 row_mask:0xf bank_mask:0xf
    v_dot2c_f32_bf16_dpp v14, v18, v235 row_newbcast:10 row_mask:0xf bank_mask:0xf
    v_dot2c_f32_bf16_dpp v15, v19, v235 row_newbcast:10 row_mask:0xf bank_mask:0xf
    v_dot2c_f32_bf16_dpp v8, v18, v236 row_newbcast:11 row_mask:0xf bank_mask:0xf
    v_dot2c_f32_bf16_dpp v9, v19, v236 row_newbcast:11 row_mask:0xf bank_mask:0xf
    v_dot2c_f32_bf16_dpp v10, v18, v237 row_newbcast:11 row_mask:0xf bank_mask:0xf
    v_dot2c_f32_bf16_dpp v11, v19, v237 row_newbcast:11 row_mask:0xf bank_mask:0xf
    v_dot2c_f32_bf16_dpp v12, v18, v238 row_newbcast:11 row_mask:0xf bank_mask:0xf
    v_dot2c_f32_bf16_dpp v13, v19, v238 row_newbcast:11 row_mask:0xf bank_mask:0xf
    v_dot2c_f32_bf16_dpp v14, v18, v239 row_newbcast:11 row_mask:0xf bank_mask:0xf
    v_dot2c_f32_bf16_dpp v15, v19, v239 row_newbcast:11 row_mask:0xf bank_mask:0xf
    v_dot2c_f32_bf16_dpp v8, v18, v240 row_newbcast:12 row_mask:0xf bank_mask:0xf
    v_dot2c_f32_bf16_dpp v9, v19, v240 row_newbcast:12 row_mask:0xf bank_mask:0xf
    v_dot2c_f32_bf16_dpp v10, v18, v241 row_newbcast:12 row_mask:0xf bank_mask:0xf
    v_dot2c_f32_bf16_dpp v11, v19, v241 row_newbcast:12 row_mask:0xf bank_mask:0xf
    v_dot2c_f32_bf16_dpp v12, v18, v242 row_newbcast:12 row_mask:0xf bank_mask:0xf
    v_dot2c_f32_bf16_dpp v13, v19, v242 row_newbcast:12 row_mask:0xf bank_mask:0xf
    v_dot2c_f32_bf16_dpp v14, v18, v243 row_newbcast:12 row_mask:0xf bank_mask:0xf
    v_dot2c_f32_bf16_dpp v15, v19, v243 row_newbcast:12 row_mask:0xf bank_mask:0xf
    v_dot2c_f32_bf16_dpp v8, v18, v244 row_newbcast:13 row_mask:0xf bank_mask:0xf
    v_dot2c_f32_bf16_dpp v9, v19, v244 row_newbcast:13 row_mask:0xf bank_mask:0xf
    v_dot2c_f32_bf16_dpp v10, v18, v245 row_newbcast:13 row_mask:0xf bank_mask:0xf
    v_dot2c_f32_bf16_dpp v11, v19, v245 row_newbcast:13 row_mask:0xf bank_mask:0xf
    v_dot2c_f32_bf16_dpp v12, v18, v246 row_newbcast:13 row_mask:0xf bank_mask:0xf
    v_dot2c_f32_bf16_dpp v13, v19, v246 row_newbcast:13 row_mask:0xf bank_mask:0xf
    v_dot2c_f32_bf16_dpp v14, v18, v247 row_newbcast:13 row_mask:0xf bank_mask:0xf
    v_dot2c_f32_bf16_dpp v15, v19, v247 row_newbcast:13 row_mask:0xf bank_mask:0xf
    v_dot2c_f32_bf16_dpp v8, v18, v248 row_newbcast:14 row_mask:0xf bank_mask:0xf
    v_dot2c_f32_bf16_dpp v9, v19, v248 row_newbcast:14 row_mask:0xf bank_mask:0xf
    v_dot2c_f32_bf16_dpp v10, v18, v249 row_newbcast:14 row_mask:0xf bank_mask:0xf
    v_dot2c_f32_bf16_dpp v11, v19, v249 row_newbcast:14 row_mask:0xf bank_mask:0xf
    v_dot2c_f32_bf16_dpp v12, v18, v250 row_newbcast:14 row_mask:0xf bank_mask:0xf
    v_dot2c_f32_bf16_dpp v13, v19, v250 row_newbcast:14 row_mask:0xf bank_mask:0xf
    v_dot2c_f32_bf16_dpp v14, v18, v251 row_newbcast:14 row_mask:0xf bank_mask:0xf
    v_dot2c_f32_bf16_dpp v15, v19, v251 row_newbcast:14 row_mask:0xf bank_mask:0xf
    v_dot2c_f32_bf16_dpp v8, v18, v252 row_newbcast:15 row_mask:0xf bank_mask:0xf
    v_dot2c_f32_bf16_dpp v9, v19, v252 row_newbcast:15 row_mask:0xf bank_mask:0xf
    v_dot2c_f32_bf16_dpp v10, v18, v253 row_newbcast:15 row_mask:0xf bank_mask:0xf
    v_dot2c_f32_bf16_dpp v11, v19, v253 row_newbcast:15 row_mask:0xf bank_mask:0xf
    v_dot2c_f32_bf16_dpp v12, v18, v254 row_newbcast:15 row_mask:0xf bank_mask:0xf
    v_dot2c_f32_bf16_dpp v13, v19, v254 row_newbcast:15 row_mask:0xf bank_mask:0xf
    v_dot2c_f32_bf16_dpp v14, v18, v255 row_newbcast:15 row_mask:0xf bank_mask:0xf
    v_dot2c_f32_bf16_dpp v15, v19, v255 row_newbcast:15 row_mask:0xf bank_mask:0xf
    v_lshlrev_b32 v30, 5, v1
    s_lshl_b32 s36, s19, 11
    v_add_u32 v30, s36, v30
    v_lshlrev_b32 v31, 2, v0
    ds_write_b128 v30, v[8:11] offset:20736
    ds_write_b128 v30, v[12:15] offset:20752
    s_lshl_b32 s36, s34, 2
    s_add_u32 s36, s36, s18
    s_lshl_b32 s37, s36, 11
    s_add_u32 s44, s14, s37
    s_addc_u32 s45, s15, 0
    s_waitcnt lgkmcnt(0)
    s_barrier
    ds_read_b32 v40, v31 offset:20736
    ds_read_b32 v41, v31 offset:22784
    ds_read_b32 v42, v31 offset:24832
    ds_read_b32 v43, v31 offset:26880
    ds_read_b32 v44, v31 offset:28928
    ds_read_b32 v45, v31 offset:30976
    ds_read_b32 v46, v31 offset:33024
    ds_read_b32 v47, v31 offset:35072
    s_waitcnt lgkmcnt(0)
    v_add_f32 v20, v40, v41
    v_add_f32 v20, v20, v42
    v_add_f32 v20, v20, v43
    v_add_f32 v20, v20, v44
    v_add_f32 v20, v20, v45
    v_add_f32 v20, v20, v46
    v_add_f32 v20, v20, v47
    global_store_dword v31, v20, s[44:45]
    s_cmp_lg_u32 s19, 0
    s_cbranch_scc1 L_k1_end
    v_mul_f32 v17, v32, v48
    v_fmac_f32 v17, v33, v49
    v_fmac_f32 v17, v34, v50
    v_fmac_f32 v17, v35, v51
    v_fmac_f32 v17, v36, v52
    v_fmac_f32 v17, v37, v53
    v_fmac_f32 v17, v38, v54
    v_fmac_f32 v17, v39, v55
    v_mov_b32 v18, v17
    s_nop 1
    v_permlane32_swap_b32 v17, v18
    s_nop 0
    v_add_f32 v17, v17, v18
    v_mov_b32 v18, v17
    s_nop 1
    v_permlane16_swap_b32 v17, v18
    s_nop 0
    v_add_f32 v17, v17, v18
    s_lshl_b32 s37, s36, 3
    s_add_u32 s37, s37, 524288
    s_add_u32 s44, s14, s37
    s_addc_u32 s45, s15, 0
    v_mov_b32 v31, 0
    v_cmp_eq_u32 vcc, 0, v1
    s_and_saveexec_b64 s[46:47], vcc
    global_store_dwordx2 v31, v[16:17], s[44:45]
L_k1_end:
    s_endpgm
.globl final_kernel
.p2align 8
.type final_kernel,@function
final_kernel:
    s_load_dwordx2 s[4:5], s[0:1], 0
    s_load_dwordx2 s[6:7], s[0:1], 72
    s_load_dwordx2 s[8:9], s[0:1], 88
    s_cmp_ge_u32 s2, 16
    s_cbranch_scc1 L_k2_end
    s_lshr_b32 s16, s2, 3
    s_and_b32 s17, s2, 7
    s_mov_b32 s28, 0x3e0293ee
    v_and_b32 v1, 15, v0
    v_lshrrev_b32 v2, 4, v0
    s_lshl_b32 s18, s16, 7
    v_lshlrev_b32 v3, 3, v2
    v_add_u32 v3, s18, v3
    v_lshlrev_b32 v4, 11, v3
    s_lshl_b32 s19, s17, 8
    v_lshl_add_u32 v5, v1, 4, s19
    v_add_u32 v4, v4, v5
    v_lshlrev_b32 v6, 3, v3
    s_lshl_b32 s18, s16, 11
    v_lshl_add_u32 v7, v2, 12, s18
    v_add_u32 v7, v7, v5
    s_waitcnt lgkmcnt(0)
    s_add_u32 s10, s8, 524288
    s_addc_u32 s11, s9, 0
    s_add_u32 s12, s8, 1048576
    s_addc_u32 s13, s9, 0
    s_mov_b32 s14, 176128
    s_mov_b32 s15, 0x00020000
    global_load_dwordx4 v[16:19], v6, s[10:11] offset:0
    global_load_dwordx4 v[20:23], v6, s[10:11] offset:16
    global_load_dwordx4 v[24:27], v6, s[10:11] offset:32
    global_load_dwordx4 v[28:31], v6, s[10:11] offset:48
    v_add_u32 v8, 0x2000, v4
    global_load_dwordx4 v[32:35], v4, s[8:9] offset:0
    v_add_u32 v9, 0x4000, v4
    global_load_dwordx4 v[36:39], v4, s[8:9] offset:2048
    global_load_dwordx4 v[40:43], v8, s[8:9] offset:-4096
    global_load_dwordx4 v[44:47], v8, s[8:9] offset:-2048
    global_load_dwordx4 v[48:51], v8, s[8:9] offset:0
    global_load_dwordx4 v[52:55], v8, s[8:9] offset:2048
    global_load_dwordx4 v[56:59], v9, s[8:9] offset:-4096
    global_load_dwordx4 v[60:63], v9, s[8:9] offset:-2048
    v_add_u32 v10, 0x10000, v7
    v_add_u32 v11, 0x20000, v7
    buffer_load_dwordx4 v[64:67], v7, s[12:15], 0 offen
    buffer_load_dwordx4 v[68:71], v10, s[12:15], 0 offen
    buffer_load_dwordx4 v[72:75], v11, s[12:15], 0 offen
    s_lshl_b32 s18, s16, 10
    s_lshl_b32 s19, s17, 7
    s_add_u32 s18, s18, s19
    v_and_b32 v76, 63, v0
    v_lshl_add_u32 v77, v76, 1, s18
    global_load_ushort v78, v77, s[4:5]
    s_waitcnt vmcnt(12)
    v_max3_f32 v12, v16, v18, v20
    v_max_f32 v12, v12, v22
    v_sub_f32 v16, v16, v12
    v_exp_f32 v16, v16
    v_sub_f32 v18, v18, v12
    v_exp_f32 v18, v18
    v_sub_f32 v20, v20, v12
    v_exp_f32 v20, v20
    v_sub_f32 v22, v22, v12
    v_exp_f32 v22, v22
    s_nop 0
    v_mul_f32 v13, v16, v17
    v_fmac_f32 v13, v18, v19
    v_fmac_f32 v13, v20, v21
    v_fmac_f32 v13, v22, v23
    v_rcp_f32 v13, v13
    s_nop 0
    v_mul_f32 v16, v16, v13
    v_mul_f32 v18, v18, v13
    v_mul_f32 v20, v20, v13
    v_mul_f32 v22, v22, v13
    v_max3_f32 v12, v24, v26, v28
    v_max_f32 v12, v12, v30
    v_sub_f32 v24, v24, v12
    v_exp_f32 v24, v24
    v_sub_f32 v26, v26, v12
    v_exp_f32 v26, v26
    v_sub_f32 v28, v28, v12
    v_exp_f32 v28, v28
    v_sub_f32 v30, v30, v12
    v_exp_f32 v30, v30
    s_nop 0
    v_mul_f32 v13, v24, v25
    v_fmac_f32 v13, v26, v27
    v_fmac_f32 v13, v28, v29
    v_fmac_f32 v13, v30, v31
    v_rcp_f32 v13, v13
    s_nop 0
    v_mul_f32 v24, v24, v13
    v_mul_f32 v26, v26, v13
    v_mul_f32 v28, v28, v13
    v_mul_f32 v30, v30, v13
    s_waitcnt vmcnt(4)
    v_mul_f32 v12, v16, v32
    v_mul_f32 v13, v16, v33
    v_mul_f32 v14, v16, v34
    v_mul_f32 v15, v16, v35
    v_fmac_f32 v12, v18, v36
    v_fmac_f32 v13, v18, v37
    v_fmac_f32 v14, v18, v38
    v_fmac_f32 v15, v18, v39
    v_fmac_f32 v12, v20, v40
    v_fmac_f32 v13, v20, v41
    v_fmac_f32 v14, v20, v42
    v_fmac_f32 v15, v20, v43
    v_fmac_f32 v12, v22, v44
    v_fmac_f32 v13, v22, v45
    v_fmac_f32 v14, v22, v46
    v_fmac_f32 v15, v22, v47
    v_fmac_f32 v12, v24, v48
    v_fmac_f32 v13, v24, v49
    v_fmac_f32 v14, v24, v50
    v_fmac_f32 v15, v24, v51
    v_fmac_f32 v12, v26, v52
    v_fmac_f32 v13, v26, v53
    v_fmac_f32 v14, v26, v54
    v_fmac_f32 v15, v26, v55
    v_fmac_f32 v12, v28, v56
    v_fmac_f32 v13, v28, v57
    v_fmac_f32 v14, v28, v58
    v_fmac_f32 v15, v28, v59
    v_fmac_f32 v12, v30, v60
    v_fmac_f32 v13, v30, v61
    v_fmac_f32 v14, v30, v62
    v_fmac_f32 v15, v30, v63
    s_waitcnt vmcnt(1)
    v_add_f32 v64, v64, v68
    v_add_f32 v64, v64, v72
    v_add_f32 v65, v65, v69
    v_add_f32 v65, v65, v73
    v_add_f32 v66, v66, v70
    v_add_f32 v66, v66, v74
    v_add_f32 v67, v67, v71
    v_add_f32 v67, v67, v75
    v_lshlrev_b32 v3, 8, v2
    v_lshl_add_u32 v3, v1, 4, v3
    ds_write_b128 v3, v[12:15]
    ds_write_b128 v3, v[64:67] offset:4096
    v_lshlrev_b32 v4, 2, v0
    s_waitcnt lgkmcnt(0)
    s_barrier
    v_cmp_gt_u32 vcc, 64, v0
    s_and_saveexec_b64 s[20:21], vcc
    s_cbranch_execz L_k2_end
    ds_read_b32 v16, v4 offset:0
    ds_read_b32 v32, v4 offset:4096
    ds_read_b32 v17, v4 offset:256
    ds_read_b32 v33, v4 offset:4352
    ds_read_b32 v18, v4 offset:512
    ds_read_b32 v34, v4 offset:4608
    ds_read_b32 v19, v4 offset:768
    ds_read_b32 v35, v4 offset:4864
    ds_read_b32 v20, v4 offset:1024
    ds_read_b32 v36, v4 offset:5120
    ds_read_b32 v21, v4 offset:1280
    ds_read_b32 v37, v4 offset:5376
    ds_read_b32 v22, v4 offset:1536
    ds_read_b32 v38, v4 offset:5632
    ds_read_b32 v23, v4 offset:1792
    ds_read_b32 v39, v4 offset:5888
    ds_read_b32 v24, v4 offset:2048
    ds_read_b32 v40, v4 offset:6144
    ds_read_b32 v25, v4 offset:2304
    ds_read_b32 v41, v4 offset:6400
    ds_read_b32 v26, v4 offset:2560
    ds_read_b32 v42, v4 offset:6656
    ds_read_b32 v27, v4 offset:2816
    ds_read_b32 v43, v4 offset:6912
    ds_read_b32 v28, v4 offset:3072
    ds_read_b32 v44, v4 offset:7168
    ds_read_b32 v29, v4 offset:3328
    ds_read_b32 v45, v4 offset:7424
    ds_read_b32 v30, v4 offset:3584
    ds_read_b32 v46, v4 offset:7680
    ds_read_b32 v31, v4 offset:3840
    ds_read_b32 v47, v4 offset:7936
    s_waitcnt lgkmcnt(0)
    v_add_f32 v8, v16, v17
    v_add_f32 v9, v32, v33
    v_add_f32 v8, v8, v18
    v_add_f32 v9, v9, v34
    v_add_f32 v8, v8, v19
    v_add_f32 v9, v9, v35
    v_add_f32 v8, v8, v20
    v_add_f32 v9, v9, v36
    v_add_f32 v8, v8, v21
    v_add_f32 v9, v9, v37
    v_add_f32 v8, v8, v22
    v_add_f32 v9, v9, v38
    v_add_f32 v8, v8, v23
    v_add_f32 v9, v9, v39
    v_add_f32 v8, v8, v24
    v_add_f32 v9, v9, v40
    v_add_f32 v8, v8, v25
    v_add_f32 v9, v9, v41
    v_add_f32 v8, v8, v26
    v_add_f32 v9, v9, v42
    v_add_f32 v8, v8, v27
    v_add_f32 v9, v9, v43
    v_add_f32 v8, v8, v28
    v_add_f32 v9, v9, v44
    v_add_f32 v8, v8, v29
    v_add_f32 v9, v9, v45
    v_add_f32 v8, v8, v30
    v_add_f32 v9, v9, v46
    v_add_f32 v8, v8, v31
    v_add_f32 v9, v9, v47
    v_cvt_pk_bf16_f32 v8, v8, v8
    v_and_b32 v8, 0xffff0000, v8
    v_cvt_pk_bf16_f32 v9, v9, v9
    v_and_b32 v9, 0xffff0000, v9
    v_mul_f32 v10, 0xbfb8aa3b, v9
    v_exp_f32 v10, v10
    s_nop 0
    v_add_f32 v10, 1.0, v10
    v_rcp_f32 v10, v10
    s_nop 0
    v_mul_f32 v10, v10, v9
    v_cvt_pk_bf16_f32 v10, v10, v10
    v_and_b32 v10, 0xffff0000, v10
    v_mul_f32 v10, v10, v8
    v_cvt_pk_bf16_f32 v10, v10, v10
    v_and_b32 v10, 0xffff0000, v10
    s_waitcnt vmcnt(0)
    v_lshlrev_b32 v6, 16, v78
    v_add_f32 v10, v10, v6
    v_cvt_pk_bf16_f32 v10, v10, v10
    global_store_short v77, v10, s[6:7]
L_k2_end:
    s_endpgm
.section .rodata,"a"
.p2align 6
.amdhsa_kernel recurrent_scan__gqa_block_cached__geglu_ffn__decode_kernel
  .amdhsa_next_free_vgpr 256
  .amdhsa_next_free_sgpr 96
  .amdhsa_accum_offset 256
  .amdhsa_group_segment_fixed_size 0
  .amdhsa_kernarg_size 96
  .amdhsa_user_sgpr_count 2
  .amdhsa_user_sgpr_kernarg_segment_ptr 1
  .amdhsa_system_sgpr_workgroup_id_x 1
  .amdhsa_float_denorm_mode_32 3
.end_amdhsa_kernel
.p2align 6
.amdhsa_kernel final_kernel
  .amdhsa_next_free_vgpr 80
  .amdhsa_next_free_sgpr 32
  .amdhsa_accum_offset 80
  .amdhsa_group_segment_fixed_size 0
  .amdhsa_kernarg_size 96
  .amdhsa_user_sgpr_count 2
  .amdhsa_user_sgpr_kernarg_segment_ptr 1
  .amdhsa_system_sgpr_workgroup_id_x 1
  .amdhsa_float_denorm_mode_32 3
.end_amdhsa_kernel
```
